```python
import torch

def _softmax(x, axis=-1):
    return torch.softmax(x, dim=axis)
def _gelu(x):
    return torch.nn.functional.gelu(x, approximate="tanh")
def _silu(x):
    return torch.nn.functional.silu(x)
def _sigmoid(x):
    return torch.sigmoid(x)
def _layernorm(x, axis=-1, eps=1e-5):
    m = x.mean(dim=axis, keepdim=True)
    v = x.var(dim=axis, keepdim=True, unbiased=False)
    return (x - m) / torch.sqrt(v + eps)
def _scatter_add(tgt, idx, src, axis=0):
    return tgt.clone().index_add_(axis, idx, src)
def _segment_sum(src, seg, n):
    out = torch.zeros((n,) + src.shape[1:], dtype=src.dtype)
    return out.index_add_(0, seg, src)
def _pad(x, pw):
    flat = tuple(v for pair in reversed(pw) for v in pair)
    return torch.nn.functional.pad(x, flat)

kernel_name = 'parallel_sum__ssm_conv_s4__dense_activation_relu__prompt'

def setup_inputs():

    _w = (lambda a: (lambda t: t.to(torch.bfloat16) if t.is_floating_point() else t)(torch.as_tensor(a)))
    def _A_setup():
        B, L, D, N = 1, 2048, 448, 256
        A_re = -(lambda _x: torch.exp(torch.as_tensor(_x)))((lambda *s: torch.randn(*s, dtype=torch.bfloat16) * 6.4)(D, N))
        A_im = torch.pi * (lambda *s: torch.randn(*s, dtype=torch.bfloat16) * 0.1)(D, N)
        B_re = (lambda *s: torch.randn(*s, dtype=torch.bfloat16) * 0.2)(D, N)
        B_im = (lambda *s: torch.randn(*s, dtype=torch.bfloat16) * 0.2)(D, N)
        C_re = (lambda *s: torch.randn(*s, dtype=torch.bfloat16) * 0.2)(D, N)
        C_im = (lambda *s: torch.randn(*s, dtype=torch.bfloat16) * 0.2)(D, N)
        log_dt = (lambda *s: torch.randn(*s, dtype=torch.bfloat16) * 0.1)(D) * 0.5 - 4.0
        Dskip = (lambda *s: torch.randn(*s, dtype=torch.bfloat16) * 0.1)(D)
        return {
            "u": _w((lambda *s: torch.randn(*s, dtype=torch.bfloat16) * 0.05)(B, L, D)),
            "A_re": _w(A_re),
            "A_im": _w(A_im),
            "B_re": _w(B_re),
            "B_im": _w(B_im),
            "C_re": _w(C_re),
            "C_im": _w(C_im),
            "log_dt": _w(log_dt),
            "Dskip": _w(Dskip),
        }
    _A_in = _A_setup()

    def _B_setup():
        B, S, D, Dff = 1, 2048, 448, 1792
        return {
            "x": _w((lambda *s: torch.randn(*s, dtype=torch.bfloat16) * 0.05)(B, S, D)),
            "w1": _w((lambda *s: torch.randn(*s, dtype=torch.bfloat16) * 0.05)(D, Dff)),
            "w2": _w((lambda *s: torch.randn(*s, dtype=torch.bfloat16) * 0.05)(Dff, D)),
        }
    _B_in = _B_setup()

    return {
        "A_u": _A_in["u"],
        "A_A_re": _A_in["A_re"],
        "A_A_im": _A_in["A_im"],
        "A_B_re": _A_in["B_re"],
        "A_B_im": _A_in["B_im"],
        "A_C_re": _A_in["C_re"],
        "A_C_im": _A_in["C_im"],
        "A_log_dt": _A_in["log_dt"],
        "A_Dskip": _A_in["Dskip"],
        "B_x": _B_in["x"],
        "B_w1": _B_in["w1"],
        "B_w2": _B_in["w2"],
    }

def reference(A_u, A_A_re, A_A_im, A_B_re, A_B_im, A_C_re, A_C_im, A_log_dt, A_Dskip, B_x, B_w1, B_w2):
    def _A_ref(u, A_re, A_im, B_re, B_im, C_re, C_im, log_dt, Dskip):
        Bsz, L, D = u.shape
        dt = torch.exp(log_dt)[:, None]
        A = A_re + 1j * A_im
        Bc = B_re + 1j * B_im
        Cc = C_re + 1j * C_im
        logdA = dt * A
        dB = dt * Bc
        l = (lambda x, dt: x.to(dt))(torch.arange(L), A_re.dtype)
        P = torch.exp(logdA[:, :, None] * l[None, None, :])
        K = torch.einsum("dn,dnl,dn->dl", Cc, P, dB).real
        L2 = 2 * L
        Kp = _pad(K, ((0, 0), (0, L)))
        up = (lambda x, *d: x.permute(*d))(u, 0, 2, 1)
        up = _pad(up, ((0, 0), (0, 0), (0, L)))
        Kf = (lambda x, axes=(-2,-1): torch.fft.rfft2(x.float(), dim=axes))(Kp[:, None, :], axes=(-2, -1))
        Uf = (lambda x, axes=(-2,-1): torch.fft.rfft2(x.float(), dim=axes))(up[:, :, None, :], axes=(-2, -1))
        Yf = Uf * Kf[None, :, :, :]
        y = (lambda x, s, axes=(-2,-1): torch.fft.irfft2(x, s=s, dim=axes).to(torch.bfloat16))(Yf, (1, L2), axes=(-2, -1))[:, :, 0, :L]
        y = (lambda x, *d: x.permute(*d))(y, 0, 2, 1) + u * Dskip[None, None, :]
        return y

    def _B_ref(x, w1, w2):
        h = torch.einsum("bsd,df->bsf", x, w1)
        zero = torch.zeros_like(h)
        h = torch.maximum(h, zero)
        return torch.einsum("bsf,fd->bsd", h, w2)

    x = A_u
    xn = _layernorm(x, axis=-1)
    return x + _A_ref(xn, A_A_re, A_A_im, A_B_re, A_B_im, A_C_re, A_C_im, A_log_dt, A_Dskip) + _B_ref(xn, B_w1, B_w2)
```

```asm
; @launch grid=(512,1,1) block=(256,1,1) lds=81920
.amdgcn_target "amdgcn-amd-amdhsa--gfx950"
.text
.globl parallel_sum__ssm_conv_s4__dense_activation_relu__prompt_kernel
.p2align 8
.type parallel_sum__ssm_conv_s4__dense_activation_relu__prompt_kernel,@function
parallel_sum__ssm_conv_s4__dense_activation_relu__prompt_kernel:
  s_load_dword s100, s[0:1], 0
  s_load_dword s101, s[0:1], 64
  s_cmp_lt_u32 s2, 224
  s_cbranch_scc0 L_notf
  s_mov_b32 s3, s2
  s_load_dwordx2 s[4:5], s[0:1], 0
  s_setprio 3
  s_load_dwordx2 s[6:7], s[0:1], 80
  s_load_dwordx2 s[8:9], s[0:1], 112
  s_load_dwordx2 s[50:51], s[0:1], 104
  s_and_b32 s10, s3, 7
  s_lshr_b32 s11, s3, 3
  s_and_b32 s30, s11, 3
  s_lshr_b32 s31, s11, 2
  s_lshr_b32 s12, s10, 1
  s_lshl_b32 s12, s12, 2
  s_add_u32 s12, s12, s30
  s_and_b32 s13, s10, 1
  s_mul_i32 s13, s13, 7
  s_add_u32 s13, s13, s31
  s_mul_i32 s32, s30, 7
  s_add_u32 s32, s32, 1
  s_lshr_b32 s32, s32, 1
  s_lshl_b32 s31, s31, 1
  s_add_u32 s45, s32, s31
  s_cmp_ge_u32 s45, 14
  s_cselect_b32 s32, 14, 0
  s_sub_u32 s45, s45, s32
  v_and_b32 v1, 63, v0
  v_lshrrev_b32 v2, 6, v0
  s_nop 0
  v_readfirstlane_b32 s14, v2
  s_nop 0
  s_and_b32 s15, s14, 1
  s_lshr_b32 s28, s14, 1
  s_lshl_b32 s29, s14, 11
  s_lshl_b32 s30, s12, 7
  v_lshrrev_b32 v8, 4, v1
  s_lshl_b32 s31, s14, 5
  s_add_u32 s30, s30, s31
  v_lshlrev_b32 v11, 2, v8
  s_lshl_b32 s33, s14, 3
  v_lshrrev_b32 v3, 2, v1
  v_add_u32 v10, s33, v8
  v_xor_b32 v11, v1, v11
  v_add_u32 v3, s30, v3
  v_xor_b32 v9, v1, v8
  v_mul_u32_u24 v10, 3584, v10
  v_and_b32 v11, 15, v11
  v_mul_u32_u24 v3, 896, v3
  v_and_b32 v9, 3, v9
  v_lshl_add_u32 v10, v11, 4, v10
  s_lshl_b32 s34, s13, 8
  v_lshl_add_u32 v4, v9, 4, v3
  v_add_u32 v6, s34, v10
  v_add_u32 v5, 14336, v4
  v_add_u32 v7, 14336, v6
  s_memrealtime s[46:47]
  s_waitcnt lgkmcnt(0)
  s_mov_b32 s16, s4
  s_mov_b32 s17, s5
  s_mov_b32 s18, 1835008
  s_mov_b32 s19, 0x00020000
  s_mov_b32 s20, s6
  s_mov_b32 s21, s7
  s_mov_b32 s22, 1605632
  s_mov_b32 s23, 0x00020000
  s_add_u32 s24, s8, 4194304
  s_addc_u32 s25, s9, 0
  s_mov_b32 s26, 7340032
  s_mov_b32 s27, 0x00020000
  s_mov_b32 s52, s50
  s_mov_b32 s53, s51
  s_mov_b32 s54, 256
  s_mov_b32 s55, 0x00020000
  s_add_u32 s60, s8, 16777216
  s_addc_u32 s61, s9, 0
  s_mov_b32 s62, 65536
  s_mov_b32 s63, 0x00020000
  s_cmp_lg_u32 s3, 0
  s_cbranch_scc1 L_g1_nn
  s_or_b32 s46, s46, 1
  v_cmp_eq_u32 vcc, 0, v0
  s_nop 0
  s_and_saveexec_b64 s[30:31], vcc
  v_mov_b32 v100, 0
  v_mov_b32 v101, s46
  buffer_store_dword v101, v100, s[52:55], 0 offen sc1
  s_mov_b64 exec, s[30:31]
  s_waitcnt vmcnt(0)
L_g1_nn:
  v_mov_b32 v176, 0
  s_mul_i32 s40, s45, 114688
  s_lshl_b32 s41, s45, 6
  s_add_u32 m0, s29, 0
  s_nop 0
  buffer_load_dwordx4 v6, s[20:23], s40 offen lds
  s_add_u32 m0, s29, 1024
  s_nop 0
  buffer_load_dwordx4 v7, s[20:23], s40 offen lds
  s_add_u32 m0, s29, 8192
  s_nop 0
  buffer_load_dwordx4 v4, s[16:19], s41 offen lds
  s_add_u32 m0, s29, 9216
  s_nop 0
  buffer_load_dwordx4 v5, s[16:19], s41 offen lds
  s_add_u32 s45, s45, 1
  s_cmp_eq_u32 s45, 14
  s_cselect_b32 s45, 0, s45
  s_mul_i32 s40, s45, 114688
  s_lshl_b32 s41, s45, 6
  s_add_u32 m0, s29, 16384
  s_nop 0
  buffer_load_dwordx4 v6, s[20:23], s40 offen lds
  s_add_u32 m0, s29, 17408
  s_nop 0
  buffer_load_dwordx4 v7, s[20:23], s40 offen lds
  s_add_u32 m0, s29, 24576
  s_nop 0
  buffer_load_dwordx4 v4, s[16:19], s41 offen lds
  s_add_u32 m0, s29, 25600
  s_nop 0
  buffer_load_dwordx4 v5, s[16:19], s41 offen lds
  s_add_u32 s45, s45, 1
  s_cmp_eq_u32 s45, 14
  s_cselect_b32 s45, 0, s45
  s_mul_i32 s40, s45, 114688
  s_lshl_b32 s41, s45, 6
  s_add_u32 m0, s29, 32768
  s_nop 0
  buffer_load_dwordx4 v6, s[20:23], s40 offen lds
  s_add_u32 m0, s29, 33792
  s_nop 0
  buffer_load_dwordx4 v7, s[20:23], s40 offen lds
  s_add_u32 m0, s29, 40960
  s_nop 0
  buffer_load_dwordx4 v4, s[16:19], s41 offen lds
  s_add_u32 m0, s29, 41984
  s_nop 0
  buffer_load_dwordx4 v5, s[16:19], s41 offen lds
  s_add_u32 s45, s45, 1
  s_cmp_eq_u32 s45, 14
  s_cselect_b32 s45, 0, s45
  s_mul_i32 s40, s45, 114688
  s_lshl_b32 s41, s45, 6
  s_add_u32 m0, s29, 49152
  s_nop 0
  buffer_load_dwordx4 v6, s[20:23], s40 offen lds
  s_add_u32 m0, s29, 50176
  s_nop 0
  buffer_load_dwordx4 v7, s[20:23], s40 offen lds
  s_xor_b32 s30, s28, 0
  s_lshl_b32 s32, s15, 1
  s_add_u32 s30, s30, s32
  s_xor_b32 s31, s28, 1
  s_lshl_b32 s33, s15, 1
  s_add_u32 s31, s31, s33
  s_xor_b32 s34, s15, 0
  s_lshl_b32 s34, s34, 11
  v_lshrrev_b32 v3, 5, v1
  v_bfe_u32 v8, v1, 2, 2
  v_bfe_u32 v9, v1, 4, 1
  v_lshrrev_b32 v27, 5, v1
  s_lshl_b32 s36, s28, 12
  s_add_u32 s34, s34, s36
  v_lshl_add_u32 v3, v3, 3, v8
  v_lshlrev_b32 v9, 1, v9
  v_bfe_u32 v22, v1, 1, 1
  v_xor_b32 v27, v27, v8
  s_add_u32 s34, s34, 8192
  s_xor_b32 s35, s15, 1
  v_lshlrev_b32 v3, 8, v3
  v_add_u32 v9, v9, v22
  v_and_b32 v26, 31, v1
  v_lshlrev_b32 v27, 4, v27
  s_lshl_b32 s35, s35, 11
  s_lshl_b32 s37, s28, 12
  v_lshl_add_u32 v3, v9, 4, v3
  v_and_b32 v22, 1, v1
  v_lshl_add_u32 v26, v26, 6, v27
  s_add_u32 s35, s35, s37
  s_add_u32 s35, s35, 8192
  v_lshl_add_u32 v3, v22, 3, v3
  v_xor_b32 v24, s30, v8
  v_xor_b32 v25, s31, v8
  v_add_u32 v12, s34, v26
  v_add_u32 v13, s35, v26
  v_lshl_add_u32 v10, v24, 6, v3
  v_lshl_add_u32 v11, v25, 6, v3
  v_xor_b32 v14, 32, v12
  v_xor_b32 v15, 32, v13
  v_add_u32 v16, 65536, v10
  v_add_u32 v17, 65536, v11
  v_add_u32 v18, 65536, v12
  v_add_u32 v20, 65536, v14
  v_add_u32 v19, 65536, v13
  v_add_u32 v21, 65536, v15
  v_and_b32 v22, 15, v1
  v_bfe_u32 v23, v1, 4, 1
  v_cmp_eq_u32 vcc, v22, v23
  v_mov_b32 v22, 0x3f803f80
  s_nop 0
  v_cndmask_b32 v160, 0, v22, vcc
  v_mov_b32 v161, v160
  v_mov_b32 v162, v160
  v_mov_b32 v163, v160
  v_mov_b32 v164, 0
  v_mov_b32 v168, 0
  v_mov_b32 v165, 0
  v_mov_b32 v169, 0
  v_mov_b32 v166, 0
  v_mov_b32 v170, 0
  v_mov_b32 v167, 0
  v_mov_b32 v171, 0
  v_mov_b32 v56, 0
  v_mov_b32 v57, 0
  v_mov_b32 v58, 0
  v_mov_b32 v59, 0
  v_mov_b32 v60, 0
  v_mov_b32 v61, 0
  v_mov_b32 v62, 0
  v_mov_b32 v63, 0
  v_mov_b32 v64, 0
  v_mov_b32 v65, 0
  v_mov_b32 v66, 0
  v_mov_b32 v67, 0
  v_mov_b32 v68, 0
  v_mov_b32 v69, 0
  v_mov_b32 v70, 0
  v_mov_b32 v71, 0
  v_mov_b32 v72, 0
  v_mov_b32 v73, 0
  v_mov_b32 v74, 0
  v_mov_b32 v75, 0
  v_mov_b32 v76, 0
  v_mov_b32 v77, 0
  v_mov_b32 v78, 0
  v_mov_b32 v79, 0
  v_mov_b32 v80, 0
  v_mov_b32 v81, 0
  v_mov_b32 v82, 0
  v_mov_b32 v83, 0
  v_mov_b32 v84, 0
  v_mov_b32 v85, 0
  v_mov_b32 v86, 0
  v_mov_b32 v87, 0
  v_mov_b32 v88, 0
  v_mov_b32 v89, 0
  v_mov_b32 v90, 0
  v_mov_b32 v91, 0
  v_mov_b32 v92, 0
  v_mov_b32 v93, 0
  v_mov_b32 v94, 0
  v_mov_b32 v95, 0
  v_mov_b32 v96, 0
  v_mov_b32 v97, 0
  v_mov_b32 v98, 0
  v_mov_b32 v99, 0
  v_mov_b32 v100, 0
  v_mov_b32 v101, 0
  v_mov_b32 v102, 0
  v_mov_b32 v103, 0
  v_mov_b32 v104, 0
  v_mov_b32 v105, 0
  v_mov_b32 v106, 0
  v_mov_b32 v107, 0
  v_mov_b32 v108, 0
  v_mov_b32 v109, 0
  v_mov_b32 v110, 0
  v_mov_b32 v111, 0
  v_mov_b32 v112, 0
  v_mov_b32 v113, 0
  v_mov_b32 v114, 0
  v_mov_b32 v115, 0
  v_mov_b32 v116, 0
  v_mov_b32 v117, 0
  v_mov_b32 v118, 0
  v_mov_b32 v119, 0
  s_lshl_b32 s30, s28, 1
  s_add_u32 s30, s30, s15
  s_lshl_b32 s30, s30, 7
  s_lshl_b32 s31, s15, 1
  v_and_b32 v120, 1, v1
  s_add_u32 s31, s31, s28
  s_lshl_b32 s31, s31, 7
  v_lshlrev_b32 v120, 6, v120
  v_lshrrev_b32 v121, 4, v1
  s_add_u32 s31, s31, 512
  v_and_b32 v126, 31, v1
  s_xor_b32 s32, s15, 0
  v_lshl_add_u32 v122, v121, 4, v120
  s_lshl_b32 s33, s28, 1
  v_lshlrev_b32 v126, 2, v126
  s_add_u32 s32, s32, s33
  v_add_u32 v120, s30, v122
  v_add_u32 v121, s31, v122
  s_lshl_b32 s32, s32, 7
  v_add_u32 v122, s32, v126
  s_xor_b32 s32, s15, 1
  s_lshl_b32 s33, s28, 1
  s_add_u32 s32, s32, s33
  s_lshl_b32 s32, s32, 7
  s_xor_b32 s34, s28, 0
  s_lshl_b32 s35, s15, 1
  s_add_u32 s34, s34, s35
  s_lshl_b32 s34, s34, 7
  s_add_u32 s34, s34, 512
  v_add_u32 v124, s34, v126
  s_xor_b32 s34, s28, 1
  s_lshl_b32 s35, s15, 1
  s_add_u32 s34, s34, s35
  s_lshl_b32 s34, s34, 7
  s_add_u32 s34, s34, 512
  v_add_u32 v123, s32, v126
  v_add_u32 v125, s34, v126
  s_xor_b32 s36, s15, 0
  s_lshl_b32 s31, s28, 1
  s_add_u32 s36, s36, s31
  s_lshl_b32 s31, s12, 2
  s_add_u32 s36, s36, s31
  s_mul_i32 s36, s36, 114688
  s_xor_b32 s37, s15, 1
  s_lshl_b32 s31, s28, 1
  s_add_u32 s37, s37, s31
  s_lshl_b32 s31, s12, 2
  s_add_u32 s37, s37, s31
  s_mul_i32 s37, s37, 114688
  s_xor_b32 s38, s28, 0
  s_lshl_b32 s31, s15, 1
  s_add_u32 s38, s38, s31
  s_lshl_b32 s31, s13, 2
  s_add_u32 s38, s38, s31
  s_lshl_b32 s38, s38, 11
  s_xor_b32 s39, s28, 1
  s_lshl_b32 s31, s15, 1
  s_add_u32 s39, s39, s31
  s_lshl_b32 s31, s13, 2
  s_add_u32 s39, s39, s31
  s_lshl_b32 s39, s39, 11
  v_mov_b32 v128, 0
  v_mov_b32 v129, 0
  v_mov_b32 v130, 0
  v_mov_b32 v131, 0
  v_mov_b32 v132, 0
  v_mov_b32 v133, 0
  v_mov_b32 v134, 0
  v_mov_b32 v135, 0
  v_mov_b32 v136, 0
  v_mov_b32 v137, 0
  v_mov_b32 v138, 0
  v_mov_b32 v139, 0
  v_mov_b32 v140, 0
  v_mov_b32 v141, 0
  v_mov_b32 v142, 0
  v_mov_b32 v143, 0
  v_cmp_gt_u32 vcc, 32, v1
  s_nop 0
  s_mov_b64 s[42:43], vcc
  v_and_b32 v126, 15, v1
  v_cmp_gt_u32 vcc, 2, v126
  s_nop 0
  s_mov_b64 s[50:51], vcc
  v_min_u32 v126, 55, v1
  v_lshlrev_b32 v126, 4, v126
  v_add_u32 v126, 4096, v126
  s_load_dwordx2 s[6:7], s[0:1], 96
  s_and_b32 s10, s3, 7
  s_lshr_b32 s11, s3, 3
  s_and_b32 s30, s11, 3
  s_lshl_b32 s65, s10, 2
  s_add_u32 s64, s30, s65
  s_lshr_b32 s65, s11, 2
  s_and_b32 s66, s14, 1
  s_lshr_b32 s67, s14, 1
  s_mul_i32 s30, s14, 28
  s_mul_i32 s31, s30, 14
  s_lshl_b32 s32, s65, 1
  s_add_u32 s31, s31, s32
  s_add_u32 s68, s31, s66
  s_lshl_b32 s68, s68, 10
  s_xor_b32 s32, s66, 1
  s_add_u32 s69, s31, s32
  s_lshl_b32 s69, s69, 10
  s_lshl_b32 s32, s64, 1
  s_add_u32 s33, s32, s67
  s_mul_i32 s33, s33, 112
  s_add_u32 s70, s33, s30
  s_lshl_b32 s70, s70, 10
  s_xor_b32 s33, s67, 1
  s_add_u32 s33, s33, s32
  s_mul_i32 s33, s33, 112
  s_add_u32 s71, s33, s30
  s_lshl_b32 s71, s71, 10
  s_mov_b32 s44, 0
  s_waitcnt vmcnt(10)
  s_barrier
  ds_read_b64_tr_b16 v[24:25], v10 offset:0
  ds_read_b64_tr_b16 v[26:27], v10 offset:1024
  ds_read_b64_tr_b16 v[28:29], v11 offset:0
  ds_read_b64_tr_b16 v[30:31], v11 offset:1024
  ds_read_b128 v[32:35], v12 offset:0
  ds_read_b128 v[36:39], v13 offset:0
L_g1_loop:
  s_waitcnt lgkmcnt(0)
  v_mfma_f32_32x32x16_bf16 v[56:71], v[24:27], v[32:35], v[56:71]
  ds_read_b64_tr_b16 v[40:41], v10 offset:4096
  ds_read_b64_tr_b16 v[42:43], v10 offset:5120
  ds_read_b128 v[48:51], v14 offset:0
  v_mfma_f32_32x32x16_bf16 v[72:87], v[24:27], v[36:39], v[72:87]
  ds_read_b64_tr_b16 v[44:45], v11 offset:4096
  ds_read_b64_tr_b16 v[46:47], v11 offset:5120
  ds_read_b128 v[52:55], v15 offset:0
  v_mfma_f32_16x16x32_bf16 v[164:167], v[24:27], v[160:163], v[164:167]
  s_add_u32 m0, s29, 57344
  s_nop 0
  buffer_load_dwordx4 v4, s[16:19], s41 offen lds
  v_mfma_f32_32x32x16_bf16 v[88:103], v[28:31], v[32:35], v[88:103]
  s_add_u32 m0, s29, 58368
  s_nop 0
  buffer_load_dwordx4 v5, s[16:19], s41 offen lds
  v_mfma_f32_16x16x32_bf16 v[168:171], v[32:35], v[160:163], v[168:171]
  s_add_u32 s45, s45, 1
  s_cmp_eq_u32 s45, 14
  s_cselect_b32 s45, 0, s45
  s_mul_i32 s40, s45, 114688
  s_lshl_b32 s41, s45, 6
  v_mfma_f32_32x32x16_bf16 v[104:119], v[28:31], v[36:39], v[104:119]
  s_waitcnt vmcnt(8) lgkmcnt(0)
  s_barrier
  v_mfma_f32_32x32x16_bf16 v[56:71], v[40:43], v[48:51], v[56:71]
  ds_read_b64_tr_b16 v[24:25], v10 offset:16384
  ds_read_b64_tr_b16 v[26:27], v10 offset:17408
  ds_read_b128 v[32:35], v12 offset:16384
  v_mfma_f32_32x32x16_bf16 v[72:87], v[40:43], v[52:55], v[72:87]
  ds_read_b64_tr_b16 v[28:29], v11 offset:16384
  ds_read_b64_tr_b16 v[30:31], v11 offset:17408
  ds_read_b128 v[36:39], v13 offset:16384
  v_mfma_f32_16x16x32_bf16 v[164:167], v[40:43], v[160:163], v[164:167]
  s_add_u32 m0, s29, 65536
  s_nop 0
  buffer_load_dwordx4 v6, s[20:23], s40 offen lds
  v_mfma_f32_32x32x16_bf16 v[88:103], v[44:47], v[48:51], v[88:103]
  s_add_u32 m0, s29, 66560
  s_nop 0
  buffer_load_dwordx4 v7, s[20:23], s40 offen lds
  v_mfma_f32_16x16x32_bf16 v[168:171], v[48:51], v[160:163], v[168:171]
  v_mfma_f32_32x32x16_bf16 v[104:119], v[44:47], v[52:55], v[104:119]
  s_waitcnt lgkmcnt(0)
  v_mfma_f32_32x32x16_bf16 v[56:71], v[24:27], v[32:35], v[56:71]
  ds_read_b64_tr_b16 v[40:41], v10 offset:20480
  ds_read_b64_tr_b16 v[42:43], v10 offset:21504
  ds_read_b128 v[48:51], v14 offset:16384
  v_mfma_f32_32x32x16_bf16 v[72:87], v[24:27], v[36:39], v[72:87]
  ds_read_b64_tr_b16 v[44:45], v11 offset:20480
  ds_read_b64_tr_b16 v[46:47], v11 offset:21504
  ds_read_b128 v[52:55], v15 offset:16384
  v_mfma_f32_16x16x32_bf16 v[164:167], v[24:27], v[160:163], v[164:167]
  s_add_u32 m0, s29, 73728
  s_nop 0
  buffer_load_dwordx4 v4, s[16:19], s41 offen lds
  v_mfma_f32_32x32x16_bf16 v[88:103], v[28:31], v[32:35], v[88:103]
  s_add_u32 m0, s29, 74752
  s_nop 0
  buffer_load_dwordx4 v5, s[16:19], s41 offen lds
  v_mfma_f32_16x16x32_bf16 v[168:171], v[32:35], v[160:163], v[168:171]
  s_add_u32 s45, s45, 1
  s_cmp_eq_u32 s45, 14
  s_cselect_b32 s45, 0, s45
  s_mul_i32 s40, s45, 114688
  s_lshl_b32 s41, s45, 6
  v_mfma_f32_32x32x16_bf16 v[104:119], v[28:31], v[36:39], v[104:119]
  s_waitcnt vmcnt(8) lgkmcnt(0)
  s_barrier
  v_mfma_f32_32x32x16_bf16 v[56:71], v[40:43], v[48:51], v[56:71]
  ds_read_b64_tr_b16 v[24:25], v10 offset:32768
  ds_read_b64_tr_b16 v[26:27], v10 offset:33792
  ds_read_b128 v[32:35], v12 offset:32768
  v_mfma_f32_32x32x16_bf16 v[72:87], v[40:43], v[52:55], v[72:87]
  ds_read_b64_tr_b16 v[28:29], v11 offset:32768
  ds_read_b64_tr_b16 v[30:31], v11 offset:33792
  ds_read_b128 v[36:39], v13 offset:32768
  v_mfma_f32_16x16x32_bf16 v[164:167], v[40:43], v[160:163], v[164:167]
  s_add_u32 m0, s29, 0
  s_nop 0
  buffer_load_dwordx4 v6, s[20:23], s40 offen lds
  v_mfma_f32_32x32x16_bf16 v[88:103], v[44:47], v[48:51], v[88:103]
  s_add_u32 m0, s29, 1024
  s_nop 0
  buffer_load_dwordx4 v7, s[20:23], s40 offen lds
  v_mfma_f32_16x16x32_bf16 v[168:171], v[48:51], v[160:163], v[168:171]
  v_mfma_f32_32x32x16_bf16 v[104:119], v[44:47], v[52:55], v[104:119]
  s_waitcnt lgkmcnt(0)
  v_mfma_f32_32x32x16_bf16 v[56:71], v[24:27], v[32:35], v[56:71]
  ds_read_b64_tr_b16 v[40:41], v10 offset:36864
  ds_read_b64_tr_b16 v[42:43], v10 offset:37888
  ds_read_b128 v[48:51], v14 offset:32768
  v_mfma_f32_32x32x16_bf16 v[72:87], v[24:27], v[36:39], v[72:87]
  ds_read_b64_tr_b16 v[44:45], v11 offset:36864
  ds_read_b64_tr_b16 v[46:47], v11 offset:37888
  ds_read_b128 v[52:55], v15 offset:32768
  v_mfma_f32_16x16x32_bf16 v[164:167], v[24:27], v[160:163], v[164:167]
  s_add_u32 m0, s29, 8192
  s_nop 0
  buffer_load_dwordx4 v4, s[16:19], s41 offen lds
  v_mfma_f32_32x32x16_bf16 v[88:103], v[28:31], v[32:35], v[88:103]
  s_add_u32 m0, s29, 9216
  s_nop 0
  buffer_load_dwordx4 v5, s[16:19], s41 offen lds
  v_mfma_f32_16x16x32_bf16 v[168:171], v[32:35], v[160:163], v[168:171]
  s_add_u32 s45, s45, 1
  s_cmp_eq_u32 s45, 14
  s_cselect_b32 s45, 0, s45
  s_mul_i32 s40, s45, 114688
  s_lshl_b32 s41, s45, 6
  v_mfma_f32_32x32x16_bf16 v[104:119], v[28:31], v[36:39], v[104:119]
  s_waitcnt vmcnt(8) lgkmcnt(0)
  s_barrier
  v_mfma_f32_32x32x16_bf16 v[56:71], v[40:43], v[48:51], v[56:71]
  ds_read_b64_tr_b16 v[24:25], v10 offset:49152
  ds_read_b64_tr_b16 v[26:27], v10 offset:50176
  ds_read_b128 v[32:35], v12 offset:49152
  v_mfma_f32_32x32x16_bf16 v[72:87], v[40:43], v[52:55], v[72:87]
  ds_read_b64_tr_b16 v[28:29], v11 offset:49152
  ds_read_b64_tr_b16 v[30:31], v11 offset:50176
  ds_read_b128 v[36:39], v13 offset:49152
  v_mfma_f32_16x16x32_bf16 v[164:167], v[40:43], v[160:163], v[164:167]
  s_add_u32 m0, s29, 16384
  s_nop 0
  buffer_load_dwordx4 v6, s[20:23], s40 offen lds
  v_mfma_f32_32x32x16_bf16 v[88:103], v[44:47], v[48:51], v[88:103]
  s_add_u32 m0, s29, 17408
  s_nop 0
  buffer_load_dwordx4 v7, s[20:23], s40 offen lds
  v_mfma_f32_16x16x32_bf16 v[168:171], v[48:51], v[160:163], v[168:171]
  v_mfma_f32_32x32x16_bf16 v[104:119], v[44:47], v[52:55], v[104:119]
  s_waitcnt lgkmcnt(0)
  v_mfma_f32_32x32x16_bf16 v[56:71], v[24:27], v[32:35], v[56:71]
  ds_read_b64_tr_b16 v[40:41], v10 offset:53248
  ds_read_b64_tr_b16 v[42:43], v10 offset:54272
  ds_read_b128 v[48:51], v14 offset:49152
  v_mfma_f32_32x32x16_bf16 v[72:87], v[24:27], v[36:39], v[72:87]
  ds_read_b64_tr_b16 v[44:45], v11 offset:53248
  ds_read_b64_tr_b16 v[46:47], v11 offset:54272
  ds_read_b128 v[52:55], v15 offset:49152
  v_mfma_f32_16x16x32_bf16 v[164:167], v[24:27], v[160:163], v[164:167]
  s_add_u32 m0, s29, 24576
  s_nop 0
  buffer_load_dwordx4 v4, s[16:19], s41 offen lds
  v_mfma_f32_32x32x16_bf16 v[88:103], v[28:31], v[32:35], v[88:103]
  s_add_u32 m0, s29, 25600
  s_nop 0
  buffer_load_dwordx4 v5, s[16:19], s41 offen lds
  v_mfma_f32_16x16x32_bf16 v[168:171], v[32:35], v[160:163], v[168:171]
  s_add_u32 s45, s45, 1
  s_cmp_eq_u32 s45, 14
  s_cselect_b32 s45, 0, s45
  s_mul_i32 s40, s45, 114688
  s_lshl_b32 s41, s45, 6
  v_mfma_f32_32x32x16_bf16 v[104:119], v[28:31], v[36:39], v[104:119]
  s_waitcnt vmcnt(8) lgkmcnt(0)
  s_barrier
  v_mfma_f32_32x32x16_bf16 v[56:71], v[40:43], v[48:51], v[56:71]
  ds_read_b64_tr_b16 v[24:25], v16 offset:0
  ds_read_b64_tr_b16 v[26:27], v16 offset:1024
  ds_read_b128 v[32:35], v18 offset:0
  v_mfma_f32_32x32x16_bf16 v[72:87], v[40:43], v[52:55], v[72:87]
  ds_read_b64_tr_b16 v[28:29], v17 offset:0
  ds_read_b64_tr_b16 v[30:31], v17 offset:1024
  ds_read_b128 v[36:39], v19 offset:0
  v_mfma_f32_16x16x32_bf16 v[164:167], v[40:43], v[160:163], v[164:167]
  s_add_u32 m0, s29, 32768
  s_nop 0
  buffer_load_dwordx4 v6, s[20:23], s40 offen lds
  v_mfma_f32_32x32x16_bf16 v[88:103], v[44:47], v[48:51], v[88:103]
  s_add_u32 m0, s29, 33792
  s_nop 0
  buffer_load_dwordx4 v7, s[20:23], s40 offen lds
  v_mfma_f32_16x16x32_bf16 v[168:171], v[48:51], v[160:163], v[168:171]
  v_mfma_f32_32x32x16_bf16 v[104:119], v[44:47], v[52:55], v[104:119]
  s_waitcnt lgkmcnt(0)
  v_mfma_f32_32x32x16_bf16 v[56:71], v[24:27], v[32:35], v[56:71]
  ds_read_b64_tr_b16 v[40:41], v16 offset:4096
  ds_read_b64_tr_b16 v[42:43], v16 offset:5120
  ds_read_b128 v[48:51], v20 offset:0
  v_mfma_f32_32x32x16_bf16 v[72:87], v[24:27], v[36:39], v[72:87]
  ds_read_b64_tr_b16 v[44:45], v17 offset:4096
  ds_read_b64_tr_b16 v[46:47], v17 offset:5120
  ds_read_b128 v[52:55], v21 offset:0
  v_mfma_f32_16x16x32_bf16 v[164:167], v[24:27], v[160:163], v[164:167]
  s_add_u32 m0, s29, 40960
  s_nop 0
  buffer_load_dwordx4 v4, s[16:19], s41 offen lds
  v_mfma_f32_32x32x16_bf16 v[88:103], v[28:31], v[32:35], v[88:103]
  s_add_u32 m0, s29, 41984
  s_nop 0
  buffer_load_dwordx4 v5, s[16:19], s41 offen lds
  v_mfma_f32_16x16x32_bf16 v[168:171], v[32:35], v[160:163], v[168:171]
  s_add_u32 s45, s45, 1
  s_cmp_eq_u32 s45, 14
  s_cselect_b32 s45, 0, s45
  s_mul_i32 s40, s45, 114688
  s_lshl_b32 s41, s45, 6
  v_mfma_f32_32x32x16_bf16 v[104:119], v[28:31], v[36:39], v[104:119]
  s_waitcnt vmcnt(8) lgkmcnt(0)
  s_barrier
  v_mfma_f32_32x32x16_bf16 v[56:71], v[40:43], v[48:51], v[56:71]
  ds_read_b64_tr_b16 v[24:25], v10 offset:0
  ds_read_b64_tr_b16 v[26:27], v10 offset:1024
  ds_read_b128 v[32:35], v12 offset:0
  v_mfma_f32_32x32x16_bf16 v[72:87], v[40:43], v[52:55], v[72:87]
  ds_read_b64_tr_b16 v[28:29], v11 offset:0
  ds_read_b64_tr_b16 v[30:31], v11 offset:1024
  ds_read_b128 v[36:39], v13 offset:0
  v_mfma_f32_16x16x32_bf16 v[164:167], v[40:43], v[160:163], v[164:167]
  s_add_u32 m0, s29, 49152
  s_nop 0
  buffer_load_dwordx4 v6, s[20:23], s40 offen lds
  v_mfma_f32_32x32x16_bf16 v[88:103], v[44:47], v[48:51], v[88:103]
  s_add_u32 m0, s29, 50176
  s_nop 0
  buffer_load_dwordx4 v7, s[20:23], s40 offen lds
  v_mfma_f32_16x16x32_bf16 v[168:171], v[48:51], v[160:163], v[168:171]
  v_mfma_f32_32x32x16_bf16 v[104:119], v[44:47], v[52:55], v[104:119]
  s_add_u32 s44, s44, 1
  s_cmp_lt_u32 s44, 2
  s_cbranch_scc1 L_g1_loop
  s_waitcnt lgkmcnt(0)
  v_mfma_f32_32x32x16_bf16 v[56:71], v[24:27], v[32:35], v[56:71]
  ds_read_b64_tr_b16 v[40:41], v10 offset:4096
  ds_read_b64_tr_b16 v[42:43], v10 offset:5120
  ds_read_b128 v[48:51], v14 offset:0
  v_mfma_f32_32x32x16_bf16 v[72:87], v[24:27], v[36:39], v[72:87]
  ds_read_b64_tr_b16 v[44:45], v11 offset:4096
  ds_read_b64_tr_b16 v[46:47], v11 offset:5120
  ds_read_b128 v[52:55], v15 offset:0
  v_mfma_f32_16x16x32_bf16 v[164:167], v[24:27], v[160:163], v[164:167]
  s_add_u32 m0, s29, 57344
  s_nop 0
  buffer_load_dwordx4 v4, s[16:19], s41 offen lds
  v_mfma_f32_32x32x16_bf16 v[88:103], v[28:31], v[32:35], v[88:103]
  s_add_u32 m0, s29, 58368
  s_nop 0
  buffer_load_dwordx4 v5, s[16:19], s41 offen lds
  v_mfma_f32_16x16x32_bf16 v[168:171], v[32:35], v[160:163], v[168:171]
  s_add_u32 s45, s45, 1
  s_cmp_eq_u32 s45, 14
  s_cselect_b32 s45, 0, s45
  s_mul_i32 s40, s45, 114688
  s_lshl_b32 s41, s45, 6
  v_mfma_f32_32x32x16_bf16 v[104:119], v[28:31], v[36:39], v[104:119]
  s_waitcnt vmcnt(8) lgkmcnt(0)
  s_barrier
  v_mfma_f32_32x32x16_bf16 v[56:71], v[40:43], v[48:51], v[56:71]
  ds_read_b64_tr_b16 v[24:25], v10 offset:16384
  ds_read_b64_tr_b16 v[26:27], v10 offset:17408
  ds_read_b128 v[32:35], v12 offset:16384
  v_mfma_f32_32x32x16_bf16 v[72:87], v[40:43], v[52:55], v[72:87]
  ds_read_b64_tr_b16 v[28:29], v11 offset:16384
  ds_read_b64_tr_b16 v[30:31], v11 offset:17408
  ds_read_b128 v[36:39], v13 offset:16384
  v_mfma_f32_16x16x32_bf16 v[164:167], v[40:43], v[160:163], v[164:167]
  v_mfma_f32_32x32x16_bf16 v[88:103], v[44:47], v[48:51], v[88:103]
  v_mfma_f32_16x16x32_bf16 v[168:171], v[48:51], v[160:163], v[168:171]
  v_mfma_f32_32x32x16_bf16 v[104:119], v[44:47], v[52:55], v[104:119]
  s_waitcnt lgkmcnt(0)
  v_mfma_f32_32x32x16_bf16 v[56:71], v[24:27], v[32:35], v[56:71]
  ds_read_b64_tr_b16 v[40:41], v10 offset:20480
  ds_read_b64_tr_b16 v[42:43], v10 offset:21504
  ds_read_b128 v[48:51], v14 offset:16384
  v_mfma_f32_32x32x16_bf16 v[72:87], v[24:27], v[36:39], v[72:87]
  ds_read_b64_tr_b16 v[44:45], v11 offset:20480
  ds_read_b64_tr_b16 v[46:47], v11 offset:21504
  ds_read_b128 v[52:55], v15 offset:16384
  v_mfma_f32_16x16x32_bf16 v[164:167], v[24:27], v[160:163], v[164:167]
  v_mfma_f32_32x32x16_bf16 v[88:103], v[28:31], v[32:35], v[88:103]
  v_mfma_f32_16x16x32_bf16 v[168:171], v[32:35], v[160:163], v[168:171]
  v_mfma_f32_32x32x16_bf16 v[104:119], v[28:31], v[36:39], v[104:119]
  s_waitcnt vmcnt(4) lgkmcnt(0)
  s_barrier
  v_mfma_f32_32x32x16_bf16 v[56:71], v[40:43], v[48:51], v[56:71]
  ds_read_b64_tr_b16 v[24:25], v10 offset:32768
  ds_read_b64_tr_b16 v[26:27], v10 offset:33792
  ds_read_b128 v[32:35], v12 offset:32768
  v_mfma_f32_32x32x16_bf16 v[72:87], v[40:43], v[52:55], v[72:87]
  ds_read_b64_tr_b16 v[28:29], v11 offset:32768
  ds_read_b64_tr_b16 v[30:31], v11 offset:33792
  ds_read_b128 v[36:39], v13 offset:32768
  v_mfma_f32_16x16x32_bf16 v[164:167], v[40:43], v[160:163], v[164:167]
  v_mfma_f32_32x32x16_bf16 v[88:103], v[44:47], v[48:51], v[88:103]
  v_mfma_f32_16x16x32_bf16 v[168:171], v[48:51], v[160:163], v[168:171]
  v_mfma_f32_32x32x16_bf16 v[104:119], v[44:47], v[52:55], v[104:119]
  buffer_load_dword v177, v176, s[52:55], 0 offen sc1
  s_waitcnt lgkmcnt(0)
  v_mfma_f32_32x32x16_bf16 v[56:71], v[24:27], v[32:35], v[56:71]
  ds_read_b64_tr_b16 v[40:41], v10 offset:36864
  ds_read_b64_tr_b16 v[42:43], v10 offset:37888
  ds_read_b128 v[48:51], v14 offset:32768
  v_mfma_f32_32x32x16_bf16 v[72:87], v[24:27], v[36:39], v[72:87]
  ds_read_b64_tr_b16 v[44:45], v11 offset:36864
  ds_read_b64_tr_b16 v[46:47], v11 offset:37888
  ds_read_b128 v[52:55], v15 offset:32768
  v_mfma_f32_16x16x32_bf16 v[164:167], v[24:27], v[160:163], v[164:167]
  v_mfma_f32_32x32x16_bf16 v[88:103], v[28:31], v[32:35], v[88:103]
  v_mfma_f32_16x16x32_bf16 v[168:171], v[32:35], v[160:163], v[168:171]
  v_mfma_f32_32x32x16_bf16 v[104:119], v[28:31], v[36:39], v[104:119]
  s_waitcnt vmcnt(0) lgkmcnt(0)
  s_barrier
  v_mfma_f32_32x32x16_bf16 v[56:71], v[40:43], v[48:51], v[56:71]
  ds_read_b64_tr_b16 v[24:25], v10 offset:49152
  ds_read_b64_tr_b16 v[26:27], v10 offset:50176
  ds_read_b128 v[32:35], v12 offset:49152
  v_mfma_f32_32x32x16_bf16 v[72:87], v[40:43], v[52:55], v[72:87]
  ds_read_b64_tr_b16 v[28:29], v11 offset:49152
  ds_read_b64_tr_b16 v[30:31], v11 offset:50176
  ds_read_b128 v[36:39], v13 offset:49152
  v_mfma_f32_16x16x32_bf16 v[164:167], v[40:43], v[160:163], v[164:167]
  v_mfma_f32_32x32x16_bf16 v[88:103], v[44:47], v[48:51], v[88:103]
  v_mfma_f32_16x16x32_bf16 v[168:171], v[48:51], v[160:163], v[168:171]
  v_mfma_f32_32x32x16_bf16 v[104:119], v[44:47], v[52:55], v[104:119]
  s_waitcnt lgkmcnt(0)
  v_mfma_f32_32x32x16_bf16 v[56:71], v[24:27], v[32:35], v[56:71]
  ds_read_b64_tr_b16 v[40:41], v10 offset:53248
  ds_read_b64_tr_b16 v[42:43], v10 offset:54272
  ds_read_b128 v[48:51], v14 offset:49152
  v_mfma_f32_32x32x16_bf16 v[72:87], v[24:27], v[36:39], v[72:87]
  ds_read_b64_tr_b16 v[44:45], v11 offset:53248
  ds_read_b64_tr_b16 v[46:47], v11 offset:54272
  ds_read_b128 v[52:55], v15 offset:49152
  v_mfma_f32_16x16x32_bf16 v[164:167], v[24:27], v[160:163], v[164:167]
  v_mfma_f32_32x32x16_bf16 v[88:103], v[28:31], v[32:35], v[88:103]
  v_mfma_f32_16x16x32_bf16 v[168:171], v[32:35], v[160:163], v[168:171]
  v_mfma_f32_32x32x16_bf16 v[104:119], v[28:31], v[36:39], v[104:119]
  s_waitcnt lgkmcnt(0)
  v_mfma_f32_32x32x16_bf16 v[56:71], v[40:43], v[48:51], v[56:71]
  v_mfma_f32_32x32x16_bf16 v[72:87], v[40:43], v[52:55], v[72:87]
  v_mfma_f32_16x16x32_bf16 v[164:167], v[40:43], v[160:163], v[164:167]
  v_mfma_f32_32x32x16_bf16 v[88:103], v[44:47], v[48:51], v[88:103]
  v_mfma_f32_16x16x32_bf16 v[168:171], v[48:51], v[160:163], v[168:171]
  v_mfma_f32_32x32x16_bf16 v[104:119], v[44:47], v[52:55], v[104:119]
  buffer_load_dword v127, v126, s[60:63], 0 offen sc1
  s_nop 4
  s_nop 0
  v_mul_f32 v168, 0x3b124925, v168
  v_mul_f32 v169, 0x3b124925, v169
  v_mul_f32 v170, 0x3b124925, v170
  v_mul_f32 v171, 0x3b124925, v171
  v_cvt_pk_bf16_f32 v24, v168, v169
  v_cvt_pk_bf16_f32 v25, v170, v171
  v_lshlrev_b32 v168, 16, v24
  v_and_b32 v169, 0xffff0000, v24
  v_lshlrev_b32 v170, 16, v25
  v_and_b32 v171, 0xffff0000, v25
  s_mov_b64 exec, s[50:51]
  ds_write_b128 v120, v[168:171]
  ds_write_b128 v121, v[164:167]
  s_mov_b64 exec, -1
  v_readfirstlane_b32 s48, v177
  s_nop 3
  s_cmp_lg_u32 s48, 0
  s_cbranch_scc1 L_g1_haven
  v_mov_b32 v48, 0
  s_mov_b32 s49, 0
L_nonce1:
  buffer_load_dword v49, v48, s[52:55], 0 offen sc1
  s_waitcnt vmcnt(0)
  v_readfirstlane_b32 s48, v49
  s_nop 3
  s_cmp_lg_u32 s48, 0
  s_cbranch_scc1 L_nonce_e2
  s_add_u32 s49, s49, 1
  s_cmp_lt_u32 s49, 200000
  s_sleep 1
  s_cbranch_scc1 L_nonce1
L_nonce_e2:
L_g1_haven:
  s_add_u32 s52, s8, 12582912
  s_addc_u32 s53, s9, 0
  s_mov_b32 s54, 1605632
  s_mov_b32 s55, 0x00020000
  s_waitcnt lgkmcnt(0)
  s_barrier
  ds_read_b32 v40, v122
  ds_read_b32 v41, v123
  ds_read_b32 v42, v124
  ds_read_b32 v43, v125
  v_lshlrev_b32 v3, 4, v1
  s_waitcnt lgkmcnt(0)
  v_cvt_pk_bf16_f32 v46, v42, v42
  v_cvt_pk_bf16_f32 v47, v43, v43
  v_cvt_pk_bf16_f32 v44, -v40, -v40
  v_lshlrev_b32 v46, 16, v46
  v_lshlrev_b32 v47, 16, v47
  v_sub_f32 v46, v42, v46
  v_sub_f32 v47, v43, v47
  v_cvt_pk_bf16_f32 v45, -v41, -v41
  v_cvt_pk_bf16_f32 v46, v42, v46
  v_cvt_pk_bf16_f32 v47, v43, v47
  v_cndmask_b32 v136, 0, v44, s[42:43]
  v_cndmask_b32 v140, 0, v45, s[42:43]
  v_cndmask_b32 v128, 0, v46, s[42:43]
  v_cndmask_b32 v132, 0, v47, s[42:43]
  s_nop 0
  v_mfma_f32_32x32x16_bf16 v[56:71], v[128:131], v[136:139], v[56:71]
  v_mfma_f32_32x32x16_bf16 v[72:87], v[128:131], v[140:143], v[72:87]
  v_mfma_f32_32x32x16_bf16 v[88:103], v[132:135], v[136:139], v[88:103]
  v_mfma_f32_32x32x16_bf16 v[104:119], v[132:135], v[140:143], v[104:119]
  s_nop 8
  v_cvt_pk_bf16_f32 v24, v56, v57
  v_cvt_pk_bf16_f32 v25, v58, v59
  v_cvt_pk_bf16_f32 v26, v60, v61
  v_cvt_pk_bf16_f32 v27, v62, v63
  v_cvt_pk_bf16_f32 v28, v64, v65
  v_cvt_pk_bf16_f32 v29, v66, v67
  v_cvt_pk_bf16_f32 v30, v68, v69
  v_cvt_pk_bf16_f32 v31, v70, v71
  v_pk_max_i16 v24, v24, 0
  v_pk_max_i16 v25, v25, 0
  v_pk_max_i16 v26, v26, 0
  v_pk_max_i16 v27, v27, 0
  v_pk_max_i16 v28, v28, 0
  v_pk_max_i16 v29, v29, 0
  v_pk_max_i16 v30, v30, 0
  v_pk_max_i16 v31, v31, 0
  s_add_u32 s30, s36, s38
  buffer_store_dwordx4 v[24:27], v3, s[24:27], s30 offen sc1
  buffer_store_dwordx4 v[28:31], v3, s[24:27], s30 offen offset:1024 sc1
  v_cvt_pk_bf16_f32 v32, v72, v73
  v_cvt_pk_bf16_f32 v33, v74, v75
  v_cvt_pk_bf16_f32 v34, v76, v77
  v_cvt_pk_bf16_f32 v35, v78, v79
  v_cvt_pk_bf16_f32 v36, v80, v81
  v_cvt_pk_bf16_f32 v37, v82, v83
  v_cvt_pk_bf16_f32 v38, v84, v85
  v_cvt_pk_bf16_f32 v39, v86, v87
  v_pk_max_i16 v32, v32, 0
  v_pk_max_i16 v33, v33, 0
  v_pk_max_i16 v34, v34, 0
  v_pk_max_i16 v35, v35, 0
  v_pk_max_i16 v36, v36, 0
  v_pk_max_i16 v37, v37, 0
  v_pk_max_i16 v38, v38, 0
  v_pk_max_i16 v39, v39, 0
  s_add_u32 s30, s37, s38
  buffer_store_dwordx4 v[32:35], v3, s[24:27], s30 offen sc1
  buffer_store_dwordx4 v[36:39], v3, s[24:27], s30 offen offset:1024 sc1
  v_cvt_pk_bf16_f32 v40, v88, v89
  v_cvt_pk_bf16_f32 v41, v90, v91
  v_cvt_pk_bf16_f32 v42, v92, v93
  v_cvt_pk_bf16_f32 v43, v94, v95
  v_cvt_pk_bf16_f32 v44, v96, v97
  v_cvt_pk_bf16_f32 v45, v98, v99
  v_cvt_pk_bf16_f32 v46, v100, v101
  v_cvt_pk_bf16_f32 v47, v102, v103
  v_pk_max_i16 v40, v40, 0
  v_pk_max_i16 v41, v41, 0
  v_pk_max_i16 v42, v42, 0
  v_pk_max_i16 v43, v43, 0
  v_pk_max_i16 v44, v44, 0
  v_pk_max_i16 v45, v45, 0
  v_pk_max_i16 v46, v46, 0
  v_pk_max_i16 v47, v47, 0
  s_add_u32 s30, s36, s39
  buffer_store_dwordx4 v[40:43], v3, s[24:27], s30 offen sc1
  buffer_store_dwordx4 v[44:47], v3, s[24:27], s30 offen offset:1024 sc1
  v_cvt_pk_bf16_f32 v48, v104, v105
  v_cvt_pk_bf16_f32 v49, v106, v107
  v_cvt_pk_bf16_f32 v50, v108, v109
  v_cvt_pk_bf16_f32 v51, v110, v111
  v_cvt_pk_bf16_f32 v52, v112, v113
  v_cvt_pk_bf16_f32 v53, v114, v115
  v_cvt_pk_bf16_f32 v54, v116, v117
  v_cvt_pk_bf16_f32 v55, v118, v119
  v_pk_max_i16 v48, v48, 0
  v_pk_max_i16 v49, v49, 0
  v_pk_max_i16 v50, v50, 0
  v_pk_max_i16 v51, v51, 0
  v_pk_max_i16 v52, v52, 0
  v_pk_max_i16 v53, v53, 0
  v_pk_max_i16 v54, v54, 0
  v_pk_max_i16 v55, v55, 0
  s_add_u32 s30, s37, s39
  buffer_store_dwordx4 v[48:51], v3, s[24:27], s30 offen sc1
  buffer_store_dwordx4 v[52:55], v3, s[24:27], s30 offen offset:1024 sc1
  s_waitcnt vmcnt(8)
  v_cmp_ne_u32 vcc, s48, v127
  s_nop 4
  s_cbranch_vccz L_g2_w2ok
  s_mov_b32 s44, 0
  s_cmp_lg_u32 s44, 0
  s_cbranch_scc1 L_wf_e4
  v_and_b32 v50, 63, v0
  v_min_u32 v50, 55, v50
  v_lshlrev_b32 v50, 4, v50
  v_add_u32 v50, 4096, v50
  s_mov_b32 s49, 0
L_wf3:
  buffer_load_dword v51, v50, s[60:63], 0 offen sc1
  s_waitcnt vmcnt(0)
  v_xor_b32 v51, s48, v51
  v_cmp_ne_u32 vcc, 0, v51
  s_nop 4
  s_cbranch_vccz L_wf_e4
  s_add_u32 s49, s49, 1
  s_cmp_lt_u32 s49, 200000
  s_sleep 1
  s_cbranch_scc1 L_wf3
L_wf_e4:
L_g2_w2ok:
  buffer_load_dwordx4 v[128:131], v3, s[52:55], s68 offen sc1
  buffer_load_dwordx4 v[132:135], v3, s[52:55], s69 offen sc1
  s_add_u32 s68, s68, 14336
  s_add_u32 s69, s69, 14336
  buffer_load_dwordx4 v[136:139], v3, s[52:55], s68 offen sc1
  buffer_load_dwordx4 v[140:143], v3, s[52:55], s69 offen sc1
  s_add_u32 s68, s68, 14336
  s_add_u32 s69, s69, 14336
  buffer_load_dwordx4 v[144:147], v3, s[52:55], s68 offen sc1
  buffer_load_dwordx4 v[148:151], v3, s[52:55], s69 offen sc1
  s_add_u32 s68, s68, 14336
  s_add_u32 s69, s69, 14336
  s_waitcnt vmcnt(0)
  s_barrier
  s_lshl_b32 s30, s12, 8
  s_lshl_b32 s31, s13, 4
  s_add_u32 s30, s30, s31
  s_add_u32 s30, s30, 5120
  v_cmp_eq_u32 vcc, 0, v0
  s_nop 0
  s_and_saveexec_b64 s[44:45], vcc
  v_mov_b32 v40, s30
  v_mov_b32 v41, s48
  buffer_store_dword v41, v40, s[60:63], 0 offen sc1
  s_mov_b64 exec, s[44:45]
  s_setprio 1
  buffer_load_dwordx4 v[152:155], v3, s[52:55], s68 offen sc1
  buffer_load_dwordx4 v[156:159], v3, s[52:55], s69 offen sc1
  s_add_u32 s68, s68, 14336
  s_add_u32 s69, s69, 14336
  buffer_load_dwordx4 v[160:163], v3, s[52:55], s68 offen sc1
  buffer_load_dwordx4 v[164:167], v3, s[52:55], s69 offen sc1
  s_add_u32 s68, s68, 14336
  s_add_u32 s69, s69, 14336
  buffer_load_dwordx4 v[168:171], v3, s[52:55], s68 offen sc1
  buffer_load_dwordx4 v[172:175], v3, s[52:55], s69 offen sc1
  s_add_u32 s68, s68, 14336
  s_add_u32 s69, s69, 14336
  buffer_load_dwordx4 v[176:179], v3, s[52:55], s68 offen sc1
  buffer_load_dwordx4 v[180:183], v3, s[52:55], s69 offen sc1
  s_add_u32 s68, s68, 14336
  s_add_u32 s69, s69, 14336
  buffer_load_dwordx4 v[184:187], v3, s[52:55], s68 offen sc1
  buffer_load_dwordx4 v[188:191], v3, s[52:55], s69 offen sc1
  s_add_u32 s68, s68, 14336
  s_add_u32 s69, s69, 14336
  buffer_load_dwordx4 v[192:195], v3, s[52:55], s68 offen sc1
  buffer_load_dwordx4 v[196:199], v3, s[52:55], s69 offen sc1
  s_add_u32 s68, s68, 14336
  s_add_u32 s69, s69, 14336
  buffer_load_dwordx4 v[200:203], v3, s[52:55], s68 offen sc1
  buffer_load_dwordx4 v[204:207], v3, s[52:55], s69 offen sc1
  s_add_u32 s68, s68, 14336
  s_add_u32 s69, s69, 14336
  buffer_load_dwordx4 v[208:211], v3, s[52:55], s68 offen sc1
  buffer_load_dwordx4 v[212:215], v3, s[52:55], s69 offen sc1
  s_add_u32 s68, s68, 14336
  s_add_u32 s69, s69, 14336
  buffer_load_dwordx4 v[216:219], v3, s[52:55], s68 offen sc1
  buffer_load_dwordx4 v[220:223], v3, s[52:55], s69 offen sc1
  s_add_u32 s68, s68, 14336
  s_add_u32 s69, s69, 14336
  buffer_load_dwordx4 v[224:227], v3, s[52:55], s68 offen sc1
  buffer_load_dwordx4 v[228:231], v3, s[52:55], s69 offen sc1
  s_add_u32 s68, s68, 14336
  s_add_u32 s69, s69, 14336
  buffer_load_dwordx4 v[232:235], v3, s[52:55], s68 offen sc1
  buffer_load_dwordx4 v[236:239], v3, s[52:55], s69 offen sc1
  s_add_u32 s68, s68, 14336
  s_add_u32 s69, s69, 14336
  buffer_load_dwordx4 v[240:243], v3, s[52:55], s68 offen sc1
  buffer_load_dwordx4 v[244:247], v3, s[52:55], s69 offen sc1
  s_add_u32 s68, s68, 14336
  s_add_u32 s69, s69, 14336
  s_lshl_b32 s34, s14, 14
  s_mov_b32 s16, s4
  s_mov_b32 s17, s5
  s_mov_b32 s18, 1835008
  s_mov_b32 s19, 0x00020000
  s_add_u32 s36, s8, 1835008
  s_addc_u32 s37, s9, 0
  s_mov_b32 s38, 8192
  s_mov_b32 s39, 0x00020000
  s_add_u32 s56, s8, 14680064
  s_addc_u32 s57, s9, 0
  s_mov_b32 s58, 1835008
  s_mov_b32 s59, 0x00020000
  v_lshrrev_b32 v4, 3, v1
  s_lshl_b32 s35, s14, 4
  v_add_u32 v4, s35, v4
  s_lshl_b32 s35, s64, 6
  v_lshrrev_b32 v5, 1, v4
  v_add_u32 v6, s35, v4
  v_xor_b32 v5, v5, v1
  s_lshl_b32 s30, s65, 7
  s_lshl_b32 s31, s65, 6
  v_and_b32 v5, 7, v5
  v_mul_u32_u24 v6, 896, v6
  v_add_u32 v248, s31, v4
  s_lshl_b32 s32, s64, 7
  v_lshl_add_u32 v6, v5, 4, v6
  v_lshlrev_b32 v248, 12, v248
  v_and_b32 v9, 7, v1
  s_lshl_b32 s33, s67, 5
  s_add_u32 s33, s33, s35
  v_add_u32 v6, s30, v6
  v_lshl_add_u32 v248, v9, 4, v248
  v_and_b32 v250, 31, v1
  v_and_b32 v251, 31, v1
  s_lshl_b32 s44, s65, 9
  v_and_b32 v252, 7, v1
  s_add_u32 s44, s44, 9216
  v_xor_b32 v7, 64, v6
  v_add_u32 v248, s32, v248
  v_add_u32 v250, s33, v250
  v_lshlrev_b32 v251, 4, v251
  v_lshlrev_b32 v252, 4, v252
  s_lshl_b32 s45, s64, 7
  s_lshl_b32 s33, s14, 14
  v_add_u32 v7, 7168, v7
  v_add_u32 v249, 32768, v248
  v_lshlrev_b32 v250, 2, v250
  v_add_u32 v251, s44, v251
  v_add_u32 v252, s45, v252
  v_add_u32 v253, s33, v3
  s_lshl_b32 s35, s14, 11
  s_add_u32 m0, s35, 65536
  s_nop 0
  buffer_load_dwordx4 v6, s[16:19], 0 offen lds
  s_add_u32 m0, s35, 66560
  s_nop 0
  buffer_load_dwordx4 v7, s[16:19], 0 offen lds
  v_lshrrev_b32 v5, 5, v1
  v_bfe_u32 v6, v1, 2, 2
  s_lshl_b32 s30, s66, 15
  v_lshl_add_u32 v5, v5, 2, v6
  v_bfe_u32 v6, v1, 4, 1
  v_lshlrev_b32 v5, 7, v5
  v_and_b32 v7, 3, v1
  v_lshl_add_u32 v5, v6, 5, v5
  s_lshl_b32 s31, s67, 6
  s_add_u32 s30, s30, s31
  v_lshl_add_u32 v5, v7, 3, v5
  s_add_u32 s30, s30, 12288
  s_lshl_b32 s32, s67, 5
  v_add_u32 v5, s30, v5
  v_and_b32 v4, 31, v1
  s_lshl_b32 s33, s66, 2
  v_and_b32 v14, 31, v1
  v_bfe_u32 v6, v1, 3, 2
  v_lshrrev_b32 v7, 2, v1
  s_lshl_b32 s30, s64, 6
  v_add_u32 v4, s32, v4
  v_bfe_u32 v15, v14, 1, 2
  s_add_u32 s30, s30, s32
  v_lshrrev_b32 v13, 5, v1
  v_lshlrev_b32 v14, 6, v14
  v_xor_b32 v6, v6, v1
  v_add_u32 v7, s30, v7
  v_bfe_u32 v10, v4, 1, 3
  v_lshlrev_b32 v12, 7, v4
  v_lshl_add_u32 v14, v13, 3, v14
  v_and_b32 v6, 3, v6
  v_mul_u32_u24 v7, 896, v7
  v_xor_b32 v10, s33, v10
  s_lshl_b32 s31, s65, 7
  v_lshl_add_u32 v12, v13, 3, v12
  v_add_u32 v14, 73728, v14
  v_lshl_add_u32 v7, v6, 4, v7
  s_lshl_b32 s33, s66, 6
  s_add_u32 s31, s31, s33
  v_lshlrev_b32 v10, 4, v10
  v_add_u32 v12, 65536, v12
  v_lshlrev_b32 v15, 4, v15
  v_add_u32 v14, s35, v14
  v_add_u32 v7, s31, v7
  v_mov_b32 v16, 0
  v_mov_b32 v17, 0
  v_mov_b32 v18, 0
  v_mov_b32 v19, 0
  v_mov_b32 v20, 0
  v_mov_b32 v21, 0
  v_mov_b32 v22, 0
  v_mov_b32 v23, 0
  v_mov_b32 v24, 0
  v_mov_b32 v25, 0
  v_mov_b32 v26, 0
  v_mov_b32 v27, 0
  v_mov_b32 v28, 0
  v_mov_b32 v29, 0
  v_mov_b32 v30, 0
  v_mov_b32 v31, 0
  v_mov_b32 v32, 0
  v_mov_b32 v33, 0
  v_mov_b32 v34, 0
  v_mov_b32 v35, 0
  v_mov_b32 v36, 0
  v_mov_b32 v37, 0
  v_mov_b32 v38, 0
  v_mov_b32 v39, 0
  v_mov_b32 v40, 0
  v_mov_b32 v41, 0
  v_mov_b32 v42, 0
  v_mov_b32 v43, 0
  v_mov_b32 v44, 0
  v_mov_b32 v45, 0
  v_mov_b32 v46, 0
  v_mov_b32 v47, 0
  v_mov_b32 v48, 0
  v_mov_b32 v49, 0
  v_mov_b32 v50, 0
  v_mov_b32 v51, 0
  v_mov_b32 v52, 0
  v_mov_b32 v53, 0
  v_mov_b32 v54, 0
  v_mov_b32 v55, 0
  v_mov_b32 v56, 0
  v_mov_b32 v57, 0
  v_mov_b32 v58, 0
  v_mov_b32 v59, 0
  v_mov_b32 v60, 0
  v_mov_b32 v61, 0
  v_mov_b32 v62, 0
  v_mov_b32 v63, 0
  v_mov_b32 v64, 0
  v_mov_b32 v65, 0
  v_mov_b32 v66, 0
  v_mov_b32 v67, 0
  v_mov_b32 v68, 0
  v_mov_b32 v69, 0
  v_mov_b32 v70, 0
  v_mov_b32 v71, 0
  v_mov_b32 v72, 0
  v_mov_b32 v73, 0
  v_mov_b32 v74, 0
  v_mov_b32 v75, 0
  v_mov_b32 v76, 0
  v_mov_b32 v77, 0
  v_mov_b32 v78, 0
  v_mov_b32 v79, 0
  s_waitcnt lgkmcnt(0)
  s_mov_b32 s20, s6
  s_mov_b32 s21, s7
  s_mov_b32 s22, 1835008
  s_mov_b32 s23, 0x00020000
  s_lshr_b32 s30, s64, 1
  s_lshl_b32 s30, s30, 8
  s_add_u32 s30, s30, 5120
  s_mul_i32 s31, s14, 7
  s_lshr_b32 s31, s31, 1
  s_lshl_b32 s31, s31, 4
  s_add_u32 s30, s30, s31
  s_mov_b32 s33, 0
  s_cmp_lg_u32 s33, 0
  s_cbranch_scc1 L_wf_e6
  v_and_b32 v8, 63, v0
  v_min_u32 v8, 3, v8
  v_lshlrev_b32 v8, 4, v8
  v_add_u32 v8, s30, v8
  s_mov_b32 s49, 0
L_wf5:
  buffer_load_dword v9, v8, s[60:63], 0 offen sc1
  s_waitcnt vmcnt(0)
  v_xor_b32 v9, s48, v9
  v_cmp_ne_u32 vcc, 0, v9
  s_nop 4
  s_cbranch_vccz L_wf_e6
  s_add_u32 s49, s49, 1
  s_cmp_lt_u32 s49, 200000
  s_sleep 1
  s_cbranch_scc1 L_wf5
L_wf_e6:
  buffer_load_dwordx4 v[80:83], v3, s[24:27], s70 offen sc1
  buffer_load_dwordx4 v[84:87], v3, s[24:27], s71 offen sc1
  s_add_u32 s70, s70, 1024
  s_add_u32 s71, s71, 1024
  buffer_load_dwordx4 v[88:91], v3, s[24:27], s70 offen sc1
  buffer_load_dwordx4 v[92:95], v3, s[24:27], s71 offen sc1
  s_add_u32 s70, s70, 1024
  s_add_u32 s71, s71, 1024
  buffer_load_dwordx4 v[96:99], v3, s[24:27], s70 offen sc1
  buffer_load_dwordx4 v[100:103], v3, s[24:27], s71 offen sc1
  s_add_u32 s70, s70, 1024
  s_add_u32 s71, s71, 1024
  buffer_load_dwordx4 v[104:107], v3, s[24:27], s70 offen sc1
  buffer_load_dwordx4 v[108:111], v3, s[24:27], s71 offen sc1
  s_add_u32 s70, s70, 1024
  s_add_u32 s71, s71, 1024
  buffer_load_dwordx4 v[112:115], v3, s[24:27], s70 offen sc1
  buffer_load_dwordx4 v[116:119], v3, s[24:27], s71 offen sc1
  s_add_u32 s70, s70, 1024
  s_add_u32 s71, s71, 1024
  s_waitcnt vmcnt(8)
  v_mfma_f32_32x32x16_bf16 v[16:31], v[128:131], v[80:83], v[16:31]
  buffer_load_dwordx4 v[120:123], v3, s[24:27], s70 offen sc1
  v_mfma_f32_32x32x16_bf16 v[32:47], v[132:135], v[80:83], v[32:47]
  buffer_load_dwordx4 v[124:127], v3, s[24:27], s71 offen sc1
  s_add_u32 s70, s70, 1024
  s_add_u32 s71, s71, 1024
  v_mfma_f32_32x32x16_bf16 v[48:63], v[128:131], v[84:87], v[48:63]
  s_add_u32 m0, s34, 0
  s_nop 0
  buffer_load_dwordx4 v3, s[52:55], s68 offen sc1 lds
  v_mfma_f32_32x32x16_bf16 v[64:79], v[132:135], v[84:87], v[64:79]
  s_add_u32 m0, s34, 1024
  s_nop 0
  buffer_load_dwordx4 v3, s[52:55], s69 offen sc1 lds
  s_add_u32 s68, s68, 14336
  s_add_u32 s69, s69, 14336
  s_waitcnt vmcnt(10)
  v_mfma_f32_32x32x16_bf16 v[16:31], v[136:139], v[88:91], v[16:31]
  buffer_load_dwordx4 v[80:83], v3, s[24:27], s70 offen sc1
  v_mfma_f32_32x32x16_bf16 v[32:47], v[140:143], v[88:91], v[32:47]
  buffer_load_dwordx4 v[84:87], v3, s[24:27], s71 offen sc1
  s_add_u32 s70, s70, 1024
  s_add_u32 s71, s71, 1024
  v_mfma_f32_32x32x16_bf16 v[48:63], v[136:139], v[92:95], v[48:63]
  s_add_u32 m0, s34, 2048
  s_nop 0
  buffer_load_dwordx4 v3, s[52:55], s68 offen sc1 lds
  v_mfma_f32_32x32x16_bf16 v[64:79], v[140:143], v[92:95], v[64:79]
  s_add_u32 m0, s34, 3072
  s_nop 0
  buffer_load_dwordx4 v3, s[52:55], s69 offen sc1 lds
  s_add_u32 s68, s68, 14336
  s_add_u32 s69, s69, 14336
  s_waitcnt vmcnt(12)
  v_mfma_f32_32x32x16_bf16 v[16:31], v[144:147], v[96:99], v[16:31]
  buffer_load_dwordx4 v[88:91], v3, s[24:27], s70 offen sc1
  v_mfma_f32_32x32x16_bf16 v[32:47], v[148:151], v[96:99], v[32:47]
  buffer_load_dwordx4 v[92:95], v3, s[24:27], s71 offen sc1
  s_add_u32 s70, s70, 1024
  s_add_u32 s71, s71, 1024
  v_mfma_f32_32x32x16_bf16 v[48:63], v[144:147], v[100:103], v[48:63]
  s_add_u32 m0, s34, 4096
  s_nop 0
  buffer_load_dwordx4 v3, s[52:55], s68 offen sc1 lds
  v_mfma_f32_32x32x16_bf16 v[64:79], v[148:151], v[100:103], v[64:79]
  s_add_u32 m0, s34, 5120
  s_nop 0
  buffer_load_dwordx4 v3, s[52:55], s69 offen sc1 lds
  s_add_u32 s68, s68, 14336
  s_add_u32 s69, s69, 14336
  s_waitcnt vmcnt(14)
  v_mfma_f32_32x32x16_bf16 v[16:31], v[152:155], v[104:107], v[16:31]
  buffer_load_dwordx4 v[96:99], v3, s[24:27], s70 offen sc1
  v_mfma_f32_32x32x16_bf16 v[32:47], v[156:159], v[104:107], v[32:47]
  buffer_load_dwordx4 v[100:103], v3, s[24:27], s71 offen sc1
  s_add_u32 s70, s70, 1024
  s_add_u32 s71, s71, 1024
  v_mfma_f32_32x32x16_bf16 v[48:63], v[152:155], v[108:111], v[48:63]
  s_add_u32 m0, s34, 6144
  s_nop 0
  buffer_load_dwordx4 v3, s[52:55], s68 offen sc1 lds
  v_mfma_f32_32x32x16_bf16 v[64:79], v[156:159], v[108:111], v[64:79]
  s_add_u32 m0, s34, 7168
  s_nop 0
  buffer_load_dwordx4 v3, s[52:55], s69 offen sc1 lds
  s_add_u32 s68, s68, 14336
  s_add_u32 s69, s69, 14336
  s_waitcnt vmcnt(16)
  v_mfma_f32_32x32x16_bf16 v[16:31], v[160:163], v[112:115], v[16:31]
  buffer_load_dwordx4 v[104:107], v3, s[24:27], s70 offen sc1
  v_mfma_f32_32x32x16_bf16 v[32:47], v[164:167], v[112:115], v[32:47]
  buffer_load_dwordx4 v[108:111], v3, s[24:27], s71 offen sc1
  s_add_u32 s70, s70, 1024
  s_add_u32 s71, s71, 1024
  v_mfma_f32_32x32x16_bf16 v[48:63], v[160:163], v[116:119], v[48:63]
  s_add_u32 m0, s34, 8192
  s_nop 0
  buffer_load_dwordx4 v3, s[52:55], s68 offen sc1 lds
  v_mfma_f32_32x32x16_bf16 v[64:79], v[164:167], v[116:119], v[64:79]
  s_add_u32 m0, s34, 9216
  s_nop 0
  buffer_load_dwordx4 v3, s[52:55], s69 offen sc1 lds
  s_add_u32 s68, s68, 14336
  s_add_u32 s69, s69, 14336
  s_waitcnt vmcnt(18)
  v_mfma_f32_32x32x16_bf16 v[16:31], v[168:171], v[120:123], v[16:31]
  buffer_load_dwordx4 v[112:115], v3, s[24:27], s70 offen sc1
  v_mfma_f32_32x32x16_bf16 v[32:47], v[172:175], v[120:123], v[32:47]
  buffer_load_dwordx4 v[116:119], v3, s[24:27], s71 offen sc1
  s_add_u32 s70, s70, 1024
  s_add_u32 s71, s71, 1024
  v_mfma_f32_32x32x16_bf16 v[48:63], v[168:171], v[124:127], v[48:63]
  s_add_u32 m0, s34, 10240
  s_nop 0
  buffer_load_dwordx4 v3, s[52:55], s68 offen sc1 lds
  v_mfma_f32_32x32x16_bf16 v[64:79], v[172:175], v[124:127], v[64:79]
  s_add_u32 m0, s34, 11264
  s_nop 0
  buffer_load_dwordx4 v3, s[52:55], s69 offen sc1 lds
  s_add_u32 s68, s68, 14336
  s_add_u32 s69, s69, 14336
  s_waitcnt vmcnt(18)
  v_mfma_f32_32x32x16_bf16 v[16:31], v[176:179], v[80:83], v[16:31]
  buffer_load_dwordx4 v[120:123], v3, s[24:27], s70 offen sc1
  v_mfma_f32_32x32x16_bf16 v[32:47], v[180:183], v[80:83], v[32:47]
  buffer_load_dwordx4 v[124:127], v3, s[24:27], s71 offen sc1
  s_add_u32 s70, s70, 1024
  s_add_u32 s71, s71, 1024
  v_mfma_f32_32x32x16_bf16 v[48:63], v[176:179], v[84:87], v[48:63]
  s_add_u32 m0, s34, 12288
  s_nop 0
  buffer_load_dwordx4 v3, s[52:55], s68 offen sc1 lds
  v_mfma_f32_32x32x16_bf16 v[64:79], v[180:183], v[84:87], v[64:79]
  s_add_u32 m0, s34, 13312
  s_nop 0
  buffer_load_dwordx4 v3, s[52:55], s69 offen sc1 lds
  s_add_u32 s68, s68, 14336
  s_add_u32 s69, s69, 14336
  s_waitcnt vmcnt(18)
  v_mfma_f32_32x32x16_bf16 v[16:31], v[184:187], v[88:91], v[16:31]
  buffer_load_dwordx4 v[80:83], v3, s[24:27], s70 offen sc1
  v_mfma_f32_32x32x16_bf16 v[32:47], v[188:191], v[88:91], v[32:47]
  buffer_load_dwordx4 v[84:87], v3, s[24:27], s71 offen sc1
  s_add_u32 s70, s70, 1024
  s_add_u32 s71, s71, 1024
  v_mfma_f32_32x32x16_bf16 v[48:63], v[184:187], v[92:95], v[48:63]
  s_add_u32 m0, s34, 14336
  s_nop 0
  buffer_load_dwordx4 v3, s[52:55], s68 offen sc1 lds
  v_mfma_f32_32x32x16_bf16 v[64:79], v[188:191], v[92:95], v[64:79]
  s_add_u32 m0, s34, 15360
  s_nop 0
  buffer_load_dwordx4 v3, s[52:55], s69 offen sc1 lds
  s_add_u32 s68, s68, 14336
  s_add_u32 s69, s69, 14336
  s_waitcnt vmcnt(18)
  v_mfma_f32_32x32x16_bf16 v[16:31], v[192:195], v[96:99], v[16:31]
  buffer_load_dwordx4 v[88:91], v3, s[24:27], s70 offen sc1
  v_mfma_f32_32x32x16_bf16 v[32:47], v[196:199], v[96:99], v[32:47]
  buffer_load_dwordx4 v[92:95], v3, s[24:27], s71 offen sc1
  s_add_u32 s70, s70, 1024
  s_add_u32 s71, s71, 1024
  v_mfma_f32_32x32x16_bf16 v[48:63], v[192:195], v[100:103], v[48:63]
  buffer_load_dwordx4 v[128:131], v3, s[52:55], s68 offen sc1
  v_mfma_f32_32x32x16_bf16 v[64:79], v[196:199], v[100:103], v[64:79]
  buffer_load_dwordx4 v[132:135], v3, s[52:55], s69 offen sc1
  s_add_u32 s68, s68, 14336
  s_add_u32 s69, s69, 14336
  s_waitcnt vmcnt(18)
  v_mfma_f32_32x32x16_bf16 v[16:31], v[200:203], v[104:107], v[16:31]
  buffer_load_dwordx4 v[96:99], v3, s[24:27], s70 offen sc1
  v_mfma_f32_32x32x16_bf16 v[32:47], v[204:207], v[104:107], v[32:47]
  buffer_load_dwordx4 v[100:103], v3, s[24:27], s71 offen sc1
  s_add_u32 s70, s70, 1024
  s_add_u32 s71, s71, 1024
  v_mfma_f32_32x32x16_bf16 v[48:63], v[200:203], v[108:111], v[48:63]
  buffer_load_dwordx4 v[136:139], v3, s[52:55], s68 offen sc1
  v_mfma_f32_32x32x16_bf16 v[64:79], v[204:207], v[108:111], v[64:79]
  buffer_load_dwordx4 v[140:143], v3, s[52:55], s69 offen sc1
  s_add_u32 s68, s68, 14336
  s_add_u32 s69, s69, 14336
  s_waitcnt vmcnt(18)
  v_mfma_f32_32x32x16_bf16 v[16:31], v[208:211], v[112:115], v[16:31]
  buffer_load_dwordx4 v[104:107], v3, s[24:27], s70 offen sc1
  v_mfma_f32_32x32x16_bf16 v[32:47], v[212:215], v[112:115], v[32:47]
  buffer_load_dwordx4 v[108:111], v3, s[24:27], s71 offen sc1
  s_add_u32 s70, s70, 1024
  s_add_u32 s71, s71, 1024
  v_mfma_f32_32x32x16_bf16 v[48:63], v[208:211], v[116:119], v[48:63]
  buffer_load_dwordx4 v[144:147], v3, s[52:55], s68 offen sc1
  v_mfma_f32_32x32x16_bf16 v[64:79], v[212:215], v[116:119], v[64:79]
  buffer_load_dwordx4 v[148:151], v3, s[52:55], s69 offen sc1
  s_add_u32 s68, s68, 14336
  s_add_u32 s69, s69, 14336
  s_waitcnt vmcnt(18)
  v_mfma_f32_32x32x16_bf16 v[16:31], v[216:219], v[120:123], v[16:31]
  buffer_load_dwordx4 v[112:115], v3, s[24:27], s70 offen sc1
  v_mfma_f32_32x32x16_bf16 v[32:47], v[220:223], v[120:123], v[32:47]
  buffer_load_dwordx4 v[116:119], v3, s[24:27], s71 offen sc1
  s_add_u32 s70, s70, 1024
  s_add_u32 s71, s71, 1024
  v_mfma_f32_32x32x16_bf16 v[48:63], v[216:219], v[124:127], v[48:63]
  buffer_load_dwordx4 v[152:155], v3, s[52:55], s68 offen sc1
  v_mfma_f32_32x32x16_bf16 v[64:79], v[220:223], v[124:127], v[64:79]
  buffer_load_dwordx4 v[156:159], v3, s[52:55], s69 offen sc1
  s_add_u32 s68, s68, 14336
  s_add_u32 s69, s69, 14336
  s_waitcnt vmcnt(18)
  v_mfma_f32_32x32x16_bf16 v[16:31], v[224:227], v[80:83], v[16:31]
  buffer_load_dwordx4 v[120:123], v3, s[24:27], s70 offen sc1
  v_mfma_f32_32x32x16_bf16 v[32:47], v[228:231], v[80:83], v[32:47]
  buffer_load_dwordx4 v[124:127], v3, s[24:27], s71 offen sc1
  s_add_u32 s70, s70, 1024
  s_add_u32 s71, s71, 1024
  v_mfma_f32_32x32x16_bf16 v[48:63], v[224:227], v[84:87], v[48:63]
  buffer_load_dwordx4 v[160:163], v3, s[52:55], s68 offen sc1
  ds_read_b128 v[216:219], v253 offset:0
  v_mfma_f32_32x32x16_bf16 v[64:79], v[228:231], v[84:87], v[64:79]
  buffer_load_dwordx4 v[164:167], v3, s[52:55], s69 offen sc1
  s_add_u32 s68, s68, 14336
  s_add_u32 s69, s69, 14336
  ds_read_b128 v[220:223], v253 offset:1024
  s_waitcnt vmcnt(18)
  v_mfma_f32_32x32x16_bf16 v[16:31], v[232:235], v[88:91], v[16:31]
  buffer_load_dwordx4 v[80:83], v3, s[24:27], s70 offen sc1
  v_mfma_f32_32x32x16_bf16 v[32:47], v[236:239], v[88:91], v[32:47]
  buffer_load_dwordx4 v[84:87], v3, s[24:27], s71 offen sc1
  s_add_u32 s70, s70, 1024
  s_add_u32 s71, s71, 1024
  v_mfma_f32_32x32x16_bf16 v[48:63], v[232:235], v[92:95], v[48:63]
  ds_read_b128 v[224:227], v253 offset:2048
  v_mfma_f32_32x32x16_bf16 v[64:79], v[236:239], v[92:95], v[64:79]
  ds_read_b128 v[228:231], v253 offset:3072
  s_waitcnt vmcnt(16)
  v_mfma_f32_32x32x16_bf16 v[16:31], v[240:243], v[96:99], v[16:31]
  buffer_load_dwordx4 v[88:91], v3, s[24:27], s70 offen sc1
  v_mfma_f32_32x32x16_bf16 v[32:47], v[244:247], v[96:99], v[32:47]
  buffer_load_dwordx4 v[92:95], v3, s[24:27], s71 offen sc1
  s_add_u32 s70, s70, 1024
  s_add_u32 s71, s71, 1024
  v_mfma_f32_32x32x16_bf16 v[48:63], v[240:243], v[100:103], v[48:63]
  ds_read_b128 v[232:235], v253 offset:4096
  v_mfma_f32_32x32x16_bf16 v[64:79], v[244:247], v[100:103], v[64:79]
  ds_read_b128 v[236:239], v253 offset:5120
  s_waitcnt vmcnt(14)
  s_waitcnt lgkmcnt(4)
  v_mfma_f32_32x32x16_bf16 v[16:31], v[216:219], v[104:107], v[16:31]
  buffer_load_dwordx4 v[96:99], v3, s[24:27], s70 offen sc1
  v_mfma_f32_32x32x16_bf16 v[32:47], v[220:223], v[104:107], v[32:47]
  buffer_load_dwordx4 v[100:103], v3, s[24:27], s71 offen sc1
  s_add_u32 s70, s70, 1024
  s_add_u32 s71, s71, 1024
  v_mfma_f32_32x32x16_bf16 v[48:63], v[216:219], v[108:111], v[48:63]
  ds_read_b128 v[240:243], v253 offset:6144
  v_mfma_f32_32x32x16_bf16 v[64:79], v[220:223], v[108:111], v[64:79]
  ds_read_b128 v[244:247], v253 offset:7168
  s_waitcnt vmcnt(12)
  s_waitcnt lgkmcnt(4)
  v_mfma_f32_32x32x16_bf16 v[16:31], v[224:227], v[112:115], v[16:31]
  buffer_load_dwordx4 v[104:107], v3, s[24:27], s70 offen sc1
  v_mfma_f32_32x32x16_bf16 v[32:47], v[228:231], v[112:115], v[32:47]
  buffer_load_dwordx4 v[108:111], v3, s[24:27], s71 offen sc1
  s_add_u32 s70, s70, 1024
  s_add_u32 s71, s71, 1024
  v_mfma_f32_32x32x16_bf16 v[48:63], v[224:227], v[116:119], v[48:63]
  ds_read_b128 v[216:219], v253 offset:8192
  v_mfma_f32_32x32x16_bf16 v[64:79], v[228:231], v[116:119], v[64:79]
  ds_read_b128 v[220:223], v253 offset:9216
  s_waitcnt vmcnt(10)
  s_waitcnt lgkmcnt(4)
  v_mfma_f32_32x32x16_bf16 v[16:31], v[232:235], v[120:123], v[16:31]
  buffer_load_dwordx4 v[112:115], v3, s[24:27], s70 offen sc1
  v_mfma_f32_32x32x16_bf16 v[32:47], v[236:239], v[120:123], v[32:47]
  buffer_load_dwordx4 v[116:119], v3, s[24:27], s71 offen sc1
  s_add_u32 s70, s70, 1024
  s_add_u32 s71, s71, 1024
  v_mfma_f32_32x32x16_bf16 v[48:63], v[232:235], v[124:127], v[48:63]
  ds_read_b128 v[224:227], v253 offset:10240
  v_mfma_f32_32x32x16_bf16 v[64:79], v[236:239], v[124:127], v[64:79]
  ds_read_b128 v[228:231], v253 offset:11264
  s_waitcnt vmcnt(8)
  s_waitcnt lgkmcnt(4)
  v_mfma_f32_32x32x16_bf16 v[16:31], v[240:243], v[80:83], v[16:31]
  buffer_load_dwordx4 v[120:123], v3, s[24:27], s70 offen sc1
  v_mfma_f32_32x32x16_bf16 v[32:47], v[244:247], v[80:83], v[32:47]
  buffer_load_dwordx4 v[124:127], v3, s[24:27], s71 offen sc1
  s_add_u32 s70, s70, 1024
  s_add_u32 s71, s71, 1024
  v_mfma_f32_32x32x16_bf16 v[48:63], v[240:243], v[84:87], v[48:63]
  ds_read_b128 v[232:235], v253 offset:12288
  v_mfma_f32_32x32x16_bf16 v[64:79], v[244:247], v[84:87], v[64:79]
  ds_read_b128 v[236:239], v253 offset:13312
  s_waitcnt vmcnt(8)
  s_waitcnt lgkmcnt(4)
  v_mfma_f32_32x32x16_bf16 v[16:31], v[216:219], v[88:91], v[16:31]
  buffer_load_dwordx4 v[80:83], v3, s[24:27], s70 offen sc1
  v_mfma_f32_32x32x16_bf16 v[32:47], v[220:223], v[88:91], v[32:47]
  buffer_load_dwordx4 v[84:87], v3, s[24:27], s71 offen sc1
  s_add_u32 s70, s70, 1024
  s_add_u32 s71, s71, 1024
  v_mfma_f32_32x32x16_bf16 v[48:63], v[216:219], v[92:95], v[48:63]
  ds_read_b128 v[240:243], v253 offset:14336
  v_mfma_f32_32x32x16_bf16 v[64:79], v[220:223], v[92:95], v[64:79]
  ds_read_b128 v[244:247], v253 offset:15360
  s_waitcnt vmcnt(8)
  s_waitcnt lgkmcnt(4)
  v_mfma_f32_32x32x16_bf16 v[16:31], v[224:227], v[96:99], v[16:31]
  buffer_load_dwordx4 v[88:91], v3, s[24:27], s70 offen sc1
  v_mfma_f32_32x32x16_bf16 v[32:47], v[228:231], v[96:99], v[32:47]
  buffer_load_dwordx4 v[92:95], v3, s[24:27], s71 offen sc1
  s_add_u32 s70, s70, 1024
  s_add_u32 s71, s71, 1024
  v_mfma_f32_32x32x16_bf16 v[48:63], v[224:227], v[100:103], v[48:63]
  v_mfma_f32_32x32x16_bf16 v[64:79], v[228:231], v[100:103], v[64:79]
  s_waitcnt vmcnt(8)
  s_waitcnt lgkmcnt(2)
  v_mfma_f32_32x32x16_bf16 v[16:31], v[232:235], v[104:107], v[16:31]
  buffer_load_dwordx4 v[96:99], v3, s[24:27], s70 offen sc1
  v_mfma_f32_32x32x16_bf16 v[32:47], v[236:239], v[104:107], v[32:47]
  buffer_load_dwordx4 v[100:103], v3, s[24:27], s71 offen sc1
  s_add_u32 s70, s70, 1024
  s_add_u32 s71, s71, 1024
  v_mfma_f32_32x32x16_bf16 v[48:63], v[232:235], v[108:111], v[48:63]
  v_mfma_f32_32x32x16_bf16 v[64:79], v[236:239], v[108:111], v[64:79]
  s_waitcnt vmcnt(8)
  s_waitcnt lgkmcnt(0)
  v_mfma_f32_32x32x16_bf16 v[16:31], v[240:243], v[112:115], v[16:31]
  buffer_load_dwordx4 v[104:107], v3, s[24:27], s70 offen sc1
  v_mfma_f32_32x32x16_bf16 v[32:47], v[244:247], v[112:115], v[32:47]
  buffer_load_dwordx4 v[108:111], v3, s[24:27], s71 offen sc1
  s_add_u32 s70, s70, 1024
  s_add_u32 s71, s71, 1024
  v_mfma_f32_32x32x16_bf16 v[48:63], v[240:243], v[116:119], v[48:63]
  v_mfma_f32_32x32x16_bf16 v[64:79], v[244:247], v[116:119], v[64:79]
  buffer_load_dword v254, v251, s[60:63], 0 offen sc1
  buffer_load_dword v255, v252, s[60:63], 0 offen offset:0 sc1
  s_waitcnt vmcnt(10)
  v_mfma_f32_32x32x16_bf16 v[16:31], v[128:131], v[120:123], v[16:31]
  v_mfma_f32_32x32x16_bf16 v[32:47], v[132:135], v[120:123], v[32:47]
  v_mfma_f32_32x32x16_bf16 v[48:63], v[128:131], v[124:127], v[48:63]
  v_mfma_f32_32x32x16_bf16 v[64:79], v[132:135], v[124:127], v[64:79]
  s_waitcnt vmcnt(8)
  v_mfma_f32_32x32x16_bf16 v[16:31], v[136:139], v[80:83], v[16:31]
  v_mfma_f32_32x32x16_bf16 v[32:47], v[140:143], v[80:83], v[32:47]
  v_mfma_f32_32x32x16_bf16 v[48:63], v[136:139], v[84:87], v[48:63]
  v_mfma_f32_32x32x16_bf16 v[64:79], v[140:143], v[84:87], v[64:79]
  s_waitcnt vmcnt(6)
  v_mfma_f32_32x32x16_bf16 v[16:31], v[144:147], v[88:91], v[16:31]
  v_mfma_f32_32x32x16_bf16 v[32:47], v[148:151], v[88:91], v[32:47]
  v_mfma_f32_32x32x16_bf16 v[48:63], v[144:147], v[92:95], v[48:63]
  v_mfma_f32_32x32x16_bf16 v[64:79], v[148:151], v[92:95], v[64:79]
  s_waitcnt vmcnt(0)
  v_xor_b32 v254, s48, v254
  v_xor_b32 v255, s48, v255
  v_or_b32 v254, v254, v255
  v_cmp_ne_u32 vcc, 0, v254
  s_mov_b32 s33, 0
  s_nop 3
  s_cbranch_vccnz L_g2_nz
  buffer_load_dwordx4 v[80:83], v248, s[56:59], 0 offen sc1
  buffer_load_dwordx4 v[84:87], v249, s[56:59], 0 offen sc1
  buffer_load_dword v11, v250, s[36:39], 0 offen sc1
  s_mov_b32 s33, 1
L_g2_nz:
  v_mfma_f32_32x32x16_bf16 v[16:31], v[152:155], v[96:99], v[16:31]
  v_mfma_f32_32x32x16_bf16 v[32:47], v[156:159], v[96:99], v[32:47]
  v_mfma_f32_32x32x16_bf16 v[48:63], v[152:155], v[100:103], v[48:63]
  v_mfma_f32_32x32x16_bf16 v[64:79], v[156:159], v[100:103], v[64:79]
  v_mfma_f32_32x32x16_bf16 v[16:31], v[160:163], v[104:107], v[16:31]
  v_mfma_f32_32x32x16_bf16 v[32:47], v[164:167], v[104:107], v[32:47]
  v_mfma_f32_32x32x16_bf16 v[48:63], v[160:163], v[108:111], v[48:63]
  v_mfma_f32_32x32x16_bf16 v[64:79], v[164:167], v[108:111], v[64:79]
  s_cmp_eq_u32 s33, 1
  s_cbranch_scc1 L_g2_zok
  s_mov_b32 s33, 0
  s_cmp_lg_u32 s33, 0
  s_cbranch_scc1 L_wf_e8
  v_and_b32 v240, 63, v0
  v_min_u32 v240, 31, v240
  v_lshlrev_b32 v240, 4, v240
  v_add_u32 v240, s44, v240
  v_and_b32 v242, 63, v0
  v_min_u32 v242, 7, v242
  v_lshlrev_b32 v242, 4, v242
  v_add_u32 v242, s45, v242
  s_mov_b32 s49, 0
L_wf7:
  buffer_load_dword v241, v240, s[60:63], 0 offen sc1
  buffer_load_dword v243, v242, s[60:63], 0 offen sc1
  s_waitcnt vmcnt(0)
  v_xor_b32 v243, s48, v243
  v_xor_b32 v241, s48, v241
  v_or_b32 v241, v241, v243
  v_cmp_ne_u32 vcc, 0, v241
  s_nop 4
  s_cbranch_vccz L_wf_e8
  s_add_u32 s49, s49, 1
  s_cmp_lt_u32 s49, 200000
  s_sleep 1
  s_cbranch_scc1 L_wf7
L_wf_e8:
  buffer_load_dwordx4 v[80:83], v248, s[56:59], 0 offen sc1
  buffer_load_dwordx4 v[84:87], v249, s[56:59], 0 offen sc1
  buffer_load_dword v11, v250, s[36:39], 0 offen sc1
L_g2_zok:
  s_nop 7
  s_nop 3
  ds_write_b128 v253, v[32:35] offset:0
  ds_write_b128 v253, v[36:39] offset:1024
  ds_write_b128 v253, v[40:43] offset:2048
  ds_write_b128 v253, v[44:47] offset:3072
  ds_write_b128 v253, v[48:51] offset:4096
  ds_write_b128 v253, v[52:55] offset:5120
  ds_write_b128 v253, v[56:59] offset:6144
  ds_write_b128 v253, v[60:63] offset:7168
  ds_write_b128 v253, v[64:67] offset:8192
  ds_write_b128 v253, v[68:71] offset:9216
  ds_write_b128 v253, v[72:75] offset:10240
  ds_write_b128 v253, v[76:79] offset:11264
  s_xor_b32 s30, s14, 1
  s_lshl_b32 s30, s30, 14
  v_add_u32 v97, s30, v3
  s_xor_b32 s30, s14, 2
  s_lshl_b32 s30, s30, 14
  v_add_u32 v98, s30, v3
  s_xor_b32 s30, s14, 3
  s_lshl_b32 s30, s30, 14
  v_add_u32 v99, s30, v3
  v_xor_b32 v100, 0, v10
  v_add_u32 v100, v100, v12
  v_xor_b32 v101, 16, v10
  v_add_u32 v101, v101, v12
  v_xor_b32 v102, 32, v10
  v_add_u32 v102, v102, v12
  v_xor_b32 v103, 48, v10
  v_add_u32 v103, v103, v12
  s_waitcnt vmcnt(0)
  ds_write_b128 v253, v[80:83] offset:12288
  ds_write_b128 v253, v[84:87] offset:13312
  s_waitcnt lgkmcnt(0)
  s_barrier
  ds_read_b128 v[112:115], v97 offset:0
  ds_read_b128 v[116:119], v97 offset:1024
  ds_read_b128 v[120:123], v97 offset:2048
  ds_read_b128 v[124:127], v97 offset:3072
  ds_read_b128 v[128:131], v98 offset:4096
  ds_read_b128 v[132:135], v98 offset:5120
  ds_read_b128 v[136:139], v98 offset:6144
  ds_read_b128 v[140:143], v98 offset:7168
  ds_read_b128 v[144:147], v99 offset:8192
  ds_read_b128 v[148:151], v99 offset:9216
  ds_read_b128 v[152:155], v99 offset:10240
  ds_read_b128 v[156:159], v99 offset:11264
  ds_read_b64_tr_b16 v[80:81], v5 offset:0
  ds_read_b64_tr_b16 v[82:83], v5 offset:1024
  ds_read_b64_tr_b16 v[84:85], v5 offset:16384
  ds_read_b64_tr_b16 v[86:87], v5 offset:17408
  s_waitcnt lgkmcnt(4)
  ds_read_b64 v[88:89], v100
  ds_read_b64 v[90:91], v101
  ds_read_b64 v[92:93], v102
  ds_read_b64 v[94:95], v103
  v_add_f32 v16, v16, v112
  v_add_f32 v128, v128, v144
  v_add_f32 v17, v17, v113
  v_add_f32 v129, v129, v145
  v_add_f32 v18, v18, v114
  v_add_f32 v130, v130, v146
  v_add_f32 v19, v19, v115
  v_add_f32 v131, v131, v147
  v_add_f32 v20, v20, v116
  v_add_f32 v132, v132, v148
  v_add_f32 v21, v21, v117
  v_add_f32 v133, v133, v149
  v_add_f32 v22, v22, v118
  v_add_f32 v134, v134, v150
  v_add_f32 v23, v23, v119
  v_add_f32 v135, v135, v151
  v_add_f32 v24, v24, v120
  v_add_f32 v136, v136, v152
  v_add_f32 v25, v25, v121
  v_add_f32 v137, v137, v153
  v_add_f32 v26, v26, v122
  v_add_f32 v138, v138, v154
  v_add_f32 v27, v27, v123
  v_add_f32 v139, v139, v155
  v_add_f32 v28, v28, v124
  v_add_f32 v140, v140, v156
  v_add_f32 v29, v29, v125
  v_add_f32 v141, v141, v157
  v_add_f32 v30, v30, v126
  v_add_f32 v142, v142, v158
  v_add_f32 v31, v31, v127
  v_add_f32 v143, v143, v159
  v_add_f32 v16, v16, v128
  v_add_f32 v17, v17, v129
  v_add_f32 v18, v18, v130
  v_add_f32 v19, v19, v131
  v_add_f32 v20, v20, v132
  v_add_f32 v21, v21, v133
  v_add_f32 v22, v22, v134
  v_add_f32 v23, v23, v135
  v_add_f32 v24, v24, v136
  v_add_f32 v25, v25, v137
  v_add_f32 v26, v26, v138
  v_add_f32 v27, v27, v139
  v_add_f32 v28, v28, v140
  v_add_f32 v29, v29, v141
  v_add_f32 v30, v30, v142
  v_add_f32 v31, v31, v143
  s_waitcnt lgkmcnt(0)
  v_lshlrev_b32 v112, 16, v88
  v_and_b32 v113, 0xffff0000, v88
  v_lshlrev_b32 v128, 16, v80
  v_and_b32 v129, 0xffff0000, v80
  v_lshlrev_b32 v114, 16, v89
  v_and_b32 v115, 0xffff0000, v89
  v_lshlrev_b32 v130, 16, v81
  v_and_b32 v131, 0xffff0000, v81
  v_lshlrev_b32 v116, 16, v90
  v_and_b32 v117, 0xffff0000, v90
  v_lshlrev_b32 v132, 16, v82
  v_and_b32 v133, 0xffff0000, v82
  v_lshlrev_b32 v118, 16, v91
  v_and_b32 v119, 0xffff0000, v91
  v_lshlrev_b32 v134, 16, v83
  v_and_b32 v135, 0xffff0000, v83
  v_lshlrev_b32 v120, 16, v92
  v_and_b32 v121, 0xffff0000, v92
  v_lshlrev_b32 v136, 16, v84
  v_and_b32 v137, 0xffff0000, v84
  v_lshlrev_b32 v122, 16, v93
  v_and_b32 v123, 0xffff0000, v93
  v_lshlrev_b32 v138, 16, v85
  v_and_b32 v139, 0xffff0000, v85
  v_lshlrev_b32 v124, 16, v94
  v_and_b32 v125, 0xffff0000, v94
  v_lshlrev_b32 v140, 16, v86
  v_and_b32 v141, 0xffff0000, v86
  v_lshlrev_b32 v126, 16, v95
  v_and_b32 v127, 0xffff0000, v95
  v_lshlrev_b32 v142, 16, v87
  v_and_b32 v143, 0xffff0000, v87
  v_add_f32 v112, v112, v128
  v_add_f32 v113, v113, v129
  v_add_f32 v114, v114, v130
  v_add_f32 v115, v115, v131
  v_add_f32 v116, v116, v132
  v_add_f32 v117, v117, v133
  v_add_f32 v118, v118, v134
  v_add_f32 v119, v119, v135
  v_add_f32 v120, v120, v136
  v_add_f32 v121, v121, v137
  v_add_f32 v122, v122, v138
  v_add_f32 v123, v123, v139
  v_add_f32 v124, v124, v140
  v_add_f32 v125, v125, v141
  v_add_f32 v126, v126, v142
  v_add_f32 v127, v127, v143
  v_fma_f32 v112, v16, v11, v112
  v_fma_f32 v113, v17, v11, v113
  v_fma_f32 v114, v18, v11, v114
  v_fma_f32 v115, v19, v11, v115
  v_fma_f32 v116, v20, v11, v116
  v_fma_f32 v117, v21, v11, v117
  v_fma_f32 v118, v22, v11, v118
  v_fma_f32 v119, v23, v11, v119
  v_fma_f32 v120, v24, v11, v120
  v_fma_f32 v121, v25, v11, v121
  v_fma_f32 v122, v26, v11, v122
  v_fma_f32 v123, v27, v11, v123
  v_fma_f32 v124, v28, v11, v124
  v_fma_f32 v125, v29, v11, v125
  v_fma_f32 v126, v30, v11, v126
  v_fma_f32 v127, v31, v11, v127
  v_cvt_pk_bf16_f32 v144, v112, v113
  v_cvt_pk_bf16_f32 v145, v114, v115
  v_cvt_pk_bf16_f32 v146, v116, v117
  v_cvt_pk_bf16_f32 v147, v118, v119
  v_cvt_pk_bf16_f32 v148, v120, v121
  v_cvt_pk_bf16_f32 v149, v122, v123
  v_cvt_pk_bf16_f32 v150, v124, v125
  v_cvt_pk_bf16_f32 v151, v126, v127
  v_xor_b32 v100, 0, v15
  v_add_u32 v100, v100, v14
  v_xor_b32 v101, 16, v15
  v_add_u32 v101, v101, v14
  v_xor_b32 v102, 32, v15
  v_add_u32 v102, v102, v14
  v_xor_b32 v103, 48, v15
  v_add_u32 v103, v103, v14
  ds_write_b64 v100, v[144:145]
  ds_write_b64 v101, v[146:147]
  ds_write_b64 v102, v[148:149]
  ds_write_b64 v103, v[150:151]
  s_lshl_b32 s35, s14, 11
  s_add_u32 s35, s35, 73728
  v_add_u32 v104, s35, v3
  v_add_u32 v107, 14336, v7
  v_mov_b32 v106, v7
  s_waitcnt lgkmcnt(0)
  ds_read_b128 v[112:115], v104
  ds_read_b128 v[116:119], v104 offset:1024
  s_waitcnt lgkmcnt(0)
  buffer_store_dwordx4 v[112:115], v106, s[20:23], 0 offen sc1
  buffer_store_dwordx4 v[116:119], v107, s[20:23], 0 offen sc1
  s_endpgm
L_notf:
  s_cmp_lt_u32 s2, 256
  s_cbranch_scc1 L_lna
  s_cmp_lt_u32 s2, 480
  s_cbranch_scc0 L_nots
  s_sub_u32 s3, s2, 256
  s_setprio 3
  s_load_dwordx16 s[56:71], s[0:1], 8
  s_load_dwordx4 s[8:11], s[0:1], 104
  s_load_dwordx2 s[4:5], s[0:1], 0
  v_and_b32 v1, 63, v0
  v_lshrrev_b32 v2, 6, v0
  s_nop 0
  v_readfirstlane_b32 s14, v2
  s_nop 0
  s_lshr_b32 s15, s14, 1
  s_and_b32 s28, s14, 1
  s_and_b32 s29, s3, 7
  s_lshr_b32 s30, s3, 3
  s_lshr_b32 s31, s30, 2
  s_lshl_b32 s31, s31, 3
  s_add_u32 s29, s29, s31
  s_lshl_b32 s29, s29, 2
  s_and_b32 s30, s30, 3
  s_add_u32 s47, s29, s30
  s_lshl_b32 s29, s47, 1
  s_add_u32 s29, s29, s15
  s_lshl_b32 s30, s29, 9
  s_lshl_b32 s31, s28, 8
  s_add_u32 s30, s30, s31
  v_lshlrev_b32 v3, 2, v1
  v_add_u32 v3, s30, v3
  s_lshl_b32 s31, s29, 1
  v_mov_b32 v4, s31
  s_waitcnt lgkmcnt(0)
  s_mov_b32 s40, s4
  s_mov_b32 s41, s5
  s_mov_b32 s42, 1835008
  s_mov_b32 s43, 0x00020000
  s_lshl_b32 s30, s3, 3
  s_lshl_b32 s31, s14, 1
  s_add_u32 s30, s30, s31
  v_lshrrev_b32 v36, 5, v1
  v_add_u32 v36, s30, v36
  v_and_b32 v37, 31, v1
  v_mul_u32_u24 v38, 896, v36
  v_lshl_add_u32 v38, v37, 4, v38
  v_mov_b32 v44, 0
  v_mov_b32 v45, 0
  v_mov_b32 v46, 0
  v_mov_b32 v47, 0
  buffer_load_dwordx4 v[40:43], v38, s[40:43], 0 offen
  s_mov_b32 exec_lo, 0x00ffffff
  s_mov_b32 exec_hi, 0x00ffffff
  buffer_load_dwordx4 v[44:47], v38, s[40:43], 0 offen offset:512
  s_mov_b64 exec, -1
  s_mov_b32 s16, s56
  s_mov_b32 s17, s57
  s_mov_b32 s18, 229376
  s_mov_b32 s19, 0x00020000
  buffer_load_dword v8, v3, s[16:19], 0 offen
  s_mov_b32 s16, s58
  s_mov_b32 s17, s59
  s_mov_b32 s18, 229376
  s_mov_b32 s19, 0x00020000
  buffer_load_dword v9, v3, s[16:19], 0 offen
  s_mov_b32 s16, s60
  s_mov_b32 s17, s61
  s_mov_b32 s18, 229376
  s_mov_b32 s19, 0x00020000
  buffer_load_dword v10, v3, s[16:19], 0 offen
  s_mov_b32 s16, s62
  s_mov_b32 s17, s63
  s_mov_b32 s18, 229376
  s_mov_b32 s19, 0x00020000
  buffer_load_dword v11, v3, s[16:19], 0 offen
  s_mov_b32 s16, s64
  s_mov_b32 s17, s65
  s_mov_b32 s18, 229376
  s_mov_b32 s19, 0x00020000
  buffer_load_dword v12, v3, s[16:19], 0 offen
  s_mov_b32 s16, s66
  s_mov_b32 s17, s67
  s_mov_b32 s18, 229376
  s_mov_b32 s19, 0x00020000
  buffer_load_dword v13, v3, s[16:19], 0 offen
  s_mov_b32 s20, s68
  s_mov_b32 s21, s69
  s_mov_b32 s22, 896
  s_mov_b32 s23, 0x00020000
  buffer_load_ushort v14, v4, s[20:23], 0 offen
  s_mov_b32 s20, s70
  s_mov_b32 s21, s71
  s_mov_b32 s22, 896
  s_mov_b32 s23, 0x00020000
  buffer_load_ushort v7, v4, s[20:23], 0 offen
  s_mov_b32 s52, s8
  s_mov_b32 s53, s9
  s_mov_b32 s54, 256
  s_mov_b32 s55, 0x00020000
  v_mov_b32 v190, 0
  s_mov_b32 s20, s10
  s_mov_b32 s21, s11
  s_mov_b32 s22, 1835008
  s_mov_b32 s23, 0x00020000
  s_add_u32 s24, s10, 14680064
  s_addc_u32 s25, s11, 0
  s_mov_b32 s26, 1835008
  s_mov_b32 s27, 0x00020000
  s_add_u32 s36, s10, 16777216
  s_addc_u32 s37, s11, 0
  s_mov_b32 s38, 65536
  s_mov_b32 s39, 0x00020000
  s_add_u32 s40, s10, 1835008
  s_addc_u32 s41, s11, 0
  s_mov_b32 s42, 8192
  s_mov_b32 s43, 0x00020000
  s_lshl_b32 s33, s14, 14
  s_mul_i32 s31, s15, 1536
  s_add_u32 s31, s31, 75776
  s_lshl_b32 s30, s28, 6
  v_add_u32 v2, s30, v1
  v_lshlrev_b32 v3, 4, v1
  v_lshlrev_b32 v96, 3, v2
  v_lshlrev_b32 v116, 3, v2
  v_sub_u32 v96, 2047, v96
  v_sub_u32 v116, 1023, v116
  v_subrev_u32 v80, 0, v96
  v_subrev_u32 v81, 1, v96
  v_cvt_f32_u32 v160, v80
  v_cvt_f32_u32 v161, v81
  v_subrev_u32 v82, 2, v96
  v_subrev_u32 v83, 3, v96
  v_cvt_pk_bf16_f32 v88, v160, v161
  v_cvt_f32_u32 v162, v82
  v_cvt_f32_u32 v163, v83
  v_and_b32 v160, 0xffff, v88
  v_cmp_gt_u32 vcc, 128, v80
  v_add_u32 v160, 4294950272, v160
  v_cvt_pk_bf16_f32 v89, v162, v163
  v_lshrrev_b32 v161, 16, v88
  v_subrev_u32 v84, 4, v96
  v_subrev_u32 v85, 5, v96
  v_cndmask_b32 v160, v160, v80, vcc
  v_add_u32 v161, 4294950272, v161
  v_cmp_gt_u32 vcc, 128, v81
  v_cvt_f32_u32 v164, v84
  v_cvt_f32_u32 v165, v85
  v_and_b32 v162, 0xffff, v89
  v_cndmask_b32 v161, v161, v81, vcc
  v_add_u32 v162, 4294950272, v162
  v_cmp_gt_u32 vcc, 128, v82
  v_cvt_pk_bf16_f32 v90, v164, v165
  v_lshrrev_b32 v163, 16, v89
  v_subrev_u32 v86, 6, v96
  v_subrev_u32 v87, 7, v96
  v_cndmask_b32 v162, v162, v82, vcc
  v_add_u32 v163, 4294950272, v163
  v_cmp_gt_u32 vcc, 128, v83
  v_cvt_f32_u32 v166, v86
  v_cvt_f32_u32 v167, v87
  v_and_b32 v164, 0xffff, v90
  v_cndmask_b32 v163, v163, v83, vcc
  v_add_u32 v164, 4294950272, v164
  v_cmp_gt_u32 vcc, 128, v84
  v_cvt_pk_bf16_f32 v91, v166, v167
  v_lshrrev_b32 v165, 16, v90
  v_cndmask_b32 v164, v164, v84, vcc
  v_subrev_u32 v100, 0, v116
  v_subrev_u32 v101, 1, v116
  v_add_u32 v165, 4294950272, v165
  v_cmp_gt_u32 vcc, 128, v85
  v_and_b32 v166, 0xffff, v91
  v_cvt_f32_u32 v168, v100
  v_cvt_f32_u32 v169, v101
  v_cndmask_b32 v165, v165, v85, vcc
  v_add_u32 v166, 4294950272, v166
  v_cmp_gt_u32 vcc, 128, v86
  v_lshrrev_b32 v167, 16, v91
  v_cvt_pk_bf16_f32 v108, v168, v169
  v_cndmask_b32 v166, v166, v86, vcc
  v_subrev_u32 v102, 2, v116
  v_subrev_u32 v103, 3, v116
  v_add_u32 v167, 4294950272, v167
  v_cmp_gt_u32 vcc, 128, v87
  v_cvt_f32_u32 v170, v102
  v_cvt_f32_u32 v171, v103
  v_and_b32 v168, 0xffff, v108
  v_cndmask_b32 v167, v167, v87, vcc
  v_add_u32 v168, 4294950272, v168
  v_cmp_gt_u32 vcc, 128, v100
  v_cvt_pk_bf16_f32 v109, v170, v171
  v_lshrrev_b32 v169, 16, v108
  v_subrev_u32 v104, 4, v116
  v_subrev_u32 v105, 5, v116
  v_cndmask_b32 v168, v168, v100, vcc
  v_add_u32 v169, 4294950272, v169
  v_cmp_gt_u32 vcc, 128, v101
  v_cvt_f32_u32 v172, v104
  v_cvt_f32_u32 v173, v105
  v_and_b32 v170, 0xffff, v109
  v_cndmask_b32 v169, v169, v101, vcc
  v_add_u32 v170, 4294950272, v170
  v_cmp_gt_u32 vcc, 128, v102
  v_cvt_pk_bf16_f32 v110, v172, v173
  v_lshrrev_b32 v171, 16, v109
  v_subrev_u32 v106, 6, v116
  v_subrev_u32 v107, 7, v116
  v_cndmask_b32 v170, v170, v102, vcc
  v_add_u32 v171, 4294950272, v171
  v_cmp_gt_u32 vcc, 128, v103
  v_cvt_f32_u32 v174, v106
  v_cvt_f32_u32 v175, v107
  v_and_b32 v172, 0xffff, v110
  v_cndmask_b32 v171, v171, v103, vcc
  v_add_u32 v172, 4294950272, v172
  v_cmp_gt_u32 vcc, 128, v104
  v_cvt_pk_bf16_f32 v111, v174, v175
  v_lshrrev_b32 v173, 16, v110
  v_bfe_u32 v18, v1, 5, 1
  v_bfe_u32 v19, v1, 3, 1
  v_bfe_u32 v20, v1, 4, 1
  v_bfe_u32 v21, v1, 1, 1
  v_cndmask_b32 v172, v172, v104, vcc
  v_add_u32 v173, 4294950272, v173
  v_cmp_gt_u32 vcc, 128, v105
  v_lshl_add_u32 v18, v18, 2, v19
  v_lshl_add_u32 v20, v20, 1, v21
  v_and_b32 v174, 0xffff, v111
  v_bfe_u32 v19, v1, 2, 1
  v_and_b32 v21, 1, v1
  v_cndmask_b32 v173, v173, v105, vcc
  v_add_u32 v174, 4294950272, v174
  v_cmp_gt_u32 vcc, 128, v106
  v_lshl_add_u32 v19, v19, 2, v20
  v_lshlrev_b32 v21, 3, v21
  v_add_u32 v22, 0, v18
  v_add_u32 v23, 2, v18
  v_lshrrev_b32 v175, 16, v111
  v_cndmask_b32 v174, v174, v106, vcc
  v_and_b32 v16, 7, v1
  v_lshlrev_b32 v17, 7, v1
  v_add_u32 v21, s33, v21
  v_xor_b32 v24, v19, v22
  v_xor_b32 v25, v19, v23
  v_mul_u32_u24 v157, 7168, v2
  v_add_u32 v175, 4294950272, v175
  v_cmp_gt_u32 vcc, 128, v107
  s_lshl_b32 s45, s29, 4
  v_add_u32 v17, s33, v17
  v_xor_b32 v144, 0, v16
  v_xor_b32 v145, 1, v16
  v_xor_b32 v146, 2, v16
  v_xor_b32 v147, 3, v16
  v_xor_b32 v148, 4, v16
  v_xor_b32 v149, 5, v16
  v_xor_b32 v150, 6, v16
  v_xor_b32 v151, 7, v16
  v_lshl_add_u32 v24, v24, 4, v21
  v_lshl_add_u32 v25, v25, 4, v21
  v_add_u32 v157, s45, v157
  v_cndmask_b32 v175, v175, v107, vcc
  v_lshl_add_u32 v144, v144, 4, v17
  v_lshl_add_u32 v145, v145, 4, v17
  v_lshl_add_u32 v146, v146, 4, v17
  v_lshl_add_u32 v147, v147, 4, v17
  v_lshl_add_u32 v148, v148, 4, v17
  v_lshl_add_u32 v149, v149, 4, v17
  v_lshl_add_u32 v150, v150, 4, v17
  v_lshl_add_u32 v151, v151, 4, v17
  v_lshl_add_u32 v152, v22, 7, v24
  v_lshl_add_u32 v153, v23, 7, v25
  v_lshlrev_b32 v156, 4, v1
  v_add_u32 v158, 917504, v157
  v_lshl_add_u32 v160, v160, 1, s31
  v_lshl_add_u32 v161, v161, 1, s31
  v_lshl_add_u32 v162, v162, 1, s31
  v_lshl_add_u32 v163, v163, 1, s31
  v_lshl_add_u32 v164, v164, 1, s31
  v_lshl_add_u32 v165, v165, 1, s31
  v_lshl_add_u32 v166, v166, 1, s31
  v_lshl_add_u32 v167, v167, 1, s31
  v_lshl_add_u32 v168, v168, 1, s31
  v_lshl_add_u32 v169, v169, 1, s31
  v_lshl_add_u32 v170, v170, 1, s31
  v_lshl_add_u32 v171, v171, 1, s31
  v_lshl_add_u32 v172, v172, 1, s31
  v_lshl_add_u32 v173, v173, 1, s31
  v_lshl_add_u32 v174, v174, 1, s31
  v_lshl_add_u32 v175, v175, 1, s31
  v_mov_b32 v112, 0
  v_mov_b32 v113, 0
  v_mov_b32 v114, 0
  v_mov_b32 v115, 0
  v_mov_b32 v116, 0
  v_mov_b32 v117, 0
  v_mov_b32 v118, 0
  v_mov_b32 v119, 0
  v_mov_b32 v120, 0
  v_mov_b32 v121, 0
  v_mov_b32 v122, 0
  v_mov_b32 v123, 0
  v_mov_b32 v124, 0
  v_mov_b32 v125, 0
  v_mov_b32 v126, 0
  v_mov_b32 v127, 0
  s_waitcnt vmcnt(8)
  buffer_load_dword v191, v190, s[52:55], 0 offen sc1
  v_lshlrev_b32 v48, 16, v40
  v_and_b32 v49, 0xffff0000, v40
  v_lshlrev_b32 v50, 16, v41
  v_and_b32 v51, 0xffff0000, v41
  v_lshlrev_b32 v52, 16, v42
  v_and_b32 v53, 0xffff0000, v42
  v_lshlrev_b32 v54, 16, v43
  v_and_b32 v55, 0xffff0000, v43
  v_lshlrev_b32 v56, 16, v44
  v_and_b32 v57, 0xffff0000, v44
  v_lshlrev_b32 v58, 16, v45
  v_and_b32 v59, 0xffff0000, v45
  v_add_f32 v64, v48, v52
  v_add_f32 v65, v49, v53
  v_add_f32 v66, v50, v54
  v_add_f32 v67, v51, v55
  v_lshlrev_b32 v60, 16, v46
  v_and_b32 v61, 0xffff0000, v46
  v_lshlrev_b32 v62, 16, v47
  v_and_b32 v63, 0xffff0000, v47
  v_add_f32 v64, v64, v56
  v_add_f32 v65, v65, v57
  v_add_f32 v66, v66, v58
  v_add_f32 v67, v67, v59
  v_add_f32 v64, v64, v60
  v_add_f32 v65, v65, v61
  v_add_f32 v66, v66, v62
  v_add_f32 v67, v67, v63
  v_add_f32 v64, v64, v65
  v_add_f32 v66, v66, v67
  v_add_f32 v64, v64, v66
  s_nop 1
  v_add_f32_dpp v64, v64, v64 quad_perm:[1,0,3,2] row_mask:0xf bank_mask:0xf
  s_nop 1
  v_add_f32_dpp v64, v64, v64 quad_perm:[2,3,0,1] row_mask:0xf bank_mask:0xf
  s_nop 1
  v_add_f32_dpp v64, v64, v64 row_half_mirror row_mask:0xf bank_mask:0xf
  s_nop 1
  v_add_f32_dpp v64, v64, v64 row_mirror row_mask:0xf bank_mask:0xf
  ds_swizzle_b32 v65, v64 offset:0x401F
  s_waitcnt lgkmcnt(0)
  v_add_f32 v64, v64, v65
  v_mul_f32 v64, 0xbb124925, v64
  v_add_f32 v68, v48, v64
  v_add_f32 v69, v49, v64
  v_add_f32 v70, v50, v64
  v_add_f32 v71, v51, v64
  v_mul_f32 v65, v68, v68
  v_mul_f32 v66, v69, v69
  v_add_f32 v72, v52, v64
  v_add_f32 v73, v53, v64
  v_fmac_f32 v65, v70, v70
  v_fmac_f32 v66, v71, v71
  v_add_f32 v74, v54, v64
  v_add_f32 v75, v55, v64
  v_fmac_f32 v65, v72, v72
  v_fmac_f32 v66, v73, v73
  v_fmac_f32 v65, v74, v74
  v_fmac_f32 v66, v75, v75
  s_mov_b32 exec_lo, 0x00ffffff
  s_mov_b32 exec_hi, 0x00ffffff
  v_add_f32 v68, v56, v64
  v_add_f32 v69, v57, v64
  v_add_f32 v70, v58, v64
  v_add_f32 v71, v59, v64
  v_fmac_f32 v65, v68, v68
  v_fmac_f32 v66, v69, v69
  v_add_f32 v72, v60, v64
  v_add_f32 v73, v61, v64
  v_fmac_f32 v65, v70, v70
  v_fmac_f32 v66, v71, v71
  v_add_f32 v74, v62, v64
  v_add_f32 v75, v63, v64
  v_fmac_f32 v65, v72, v72
  v_fmac_f32 v66, v73, v73
  v_fmac_f32 v65, v74, v74
  v_fmac_f32 v66, v75, v75
  s_mov_b64 exec, -1
  v_add_f32 v65, v65, v66
  s_nop 1
  v_add_f32_dpp v65, v65, v65 quad_perm:[1,0,3,2] row_mask:0xf bank_mask:0xf
  s_nop 1
  v_add_f32_dpp v65, v65, v65 quad_perm:[2,3,0,1] row_mask:0xf bank_mask:0xf
  s_nop 1
  v_add_f32_dpp v65, v65, v65 row_half_mirror row_mask:0xf bank_mask:0xf
  s_nop 1
  v_add_f32_dpp v65, v65, v65 row_mirror row_mask:0xf bank_mask:0xf
  ds_swizzle_b32 v66, v65 offset:0x401F
  s_waitcnt lgkmcnt(0)
  v_add_f32 v65, v65, v66
  v_mul_f32 v65, 0x3b124925, v65
  v_cvt_pk_bf16_f32 v65, v65, v64
  v_and_b32 v64, 0xffff0000, v65
  v_lshlrev_b32 v65, 16, v65
  v_add_f32 v65, 0x3727c5ac, v65
  v_cvt_pk_bf16_f32 v65, v65, v65
  v_lshlrev_b32 v65, 16, v65
  v_sqrt_f32 v65, v65
  s_nop 0
  v_cvt_pk_bf16_f32 v65, v65, v65
  v_lshlrev_b32 v65, 16, v65
  v_rcp_f32 v66, v65
  s_nop 0
  v_fma_f32 v67, -v65, v66, 2.0
  v_mul_f32 v66, v66, v67
  v_lshlrev_b32 v39, 2, v36
  s_mov_b32 exec_lo, 1
  s_mov_b32 exec_hi, 1
  buffer_store_dword v66, v39, s[40:43], 0 offen sc1
  s_mov_b64 exec, -1
  v_add_f32 v48, v48, v64
  v_add_f32 v49, v49, v64
  v_add_f32 v50, v50, v64
  v_add_f32 v51, v51, v64
  v_add_f32 v52, v52, v64
  v_add_f32 v53, v53, v64
  v_add_f32 v54, v54, v64
  v_add_f32 v55, v55, v64
  v_add_f32 v56, v56, v64
  v_add_f32 v57, v57, v64
  v_add_f32 v58, v58, v64
  v_add_f32 v59, v59, v64
  v_add_f32 v60, v60, v64
  v_add_f32 v61, v61, v64
  v_add_f32 v62, v62, v64
  v_add_f32 v63, v63, v64
  v_bfe_u32 v69, v1, 2, 2
  v_cvt_pk_bf16_f32 v40, v48, v49
  v_cvt_pk_bf16_f32 v41, v50, v51
  v_cvt_pk_bf16_f32 v42, v52, v53
  v_cvt_pk_bf16_f32 v43, v54, v55
  v_cvt_pk_bf16_f32 v44, v56, v57
  v_cvt_pk_bf16_f32 v45, v58, v59
  v_cvt_pk_bf16_f32 v46, v60, v61
  v_cvt_pk_bf16_f32 v47, v62, v63
  v_mul_u32_u24 v69, 960, v69
  v_lshrrev_b32 v70, 4, v1
  v_and_b32 v68, 7, v36
  v_lshl_add_u32 v69, v70, 5, v69
  v_lshlrev_b32 v48, 16, v40
  v_and_b32 v49, 0xffff0000, v40
  v_lshlrev_b32 v50, 16, v41
  v_and_b32 v51, 0xffff0000, v41
  v_lshlrev_b32 v52, 16, v42
  v_and_b32 v53, 0xffff0000, v42
  v_lshlrev_b32 v54, 16, v43
  v_and_b32 v55, 0xffff0000, v43
  v_lshlrev_b32 v56, 16, v44
  v_and_b32 v57, 0xffff0000, v44
  v_lshlrev_b32 v58, 16, v45
  v_and_b32 v59, 0xffff0000, v45
  v_lshlrev_b32 v60, 16, v46
  v_and_b32 v61, 0xffff0000, v46
  v_lshlrev_b32 v62, 16, v47
  v_and_b32 v63, 0xffff0000, v47
  v_mul_u32_u24 v68, 960, v68
  v_and_b32 v70, 3, v1
  v_mul_f32 v48, v48, v66
  v_mul_f32 v49, v49, v66
  v_mul_f32 v50, v50, v66
  v_mul_f32 v51, v51, v66
  v_mul_f32 v52, v52, v66
  v_mul_f32 v53, v53, v66
  v_mul_f32 v54, v54, v66
  v_mul_f32 v55, v55, v66
  v_mul_f32 v56, v56, v66
  v_mul_f32 v57, v57, v66
  v_mul_f32 v58, v58, v66
  v_mul_f32 v59, v59, v66
  v_mul_f32 v60, v60, v66
  v_mul_f32 v61, v61, v66
  v_mul_f32 v62, v62, v66
  v_mul_f32 v63, v63, v66
  v_lshl_add_u32 v68, v37, 4, v68
  v_lshl_add_u32 v69, v70, 3, v69
  s_lshl_b32 s44, s14, 7
  s_add_u32 s44, s44, 65536
  v_cvt_pk_bf16_f32 v40, v48, v49
  v_cvt_pk_bf16_f32 v41, v50, v51
  v_cvt_pk_bf16_f32 v42, v52, v53
  v_cvt_pk_bf16_f32 v43, v54, v55
  v_cvt_pk_bf16_f32 v44, v56, v57
  v_cvt_pk_bf16_f32 v45, v58, v59
  v_cvt_pk_bf16_f32 v46, v60, v61
  v_cvt_pk_bf16_f32 v47, v62, v63
  v_add_u32 v68, 65536, v68
  v_add_u32 v69, s44, v69
  v_lshlrev_b32 v70, 4, v1
  ds_write_b128 v68, v[40:43]
  s_mov_b32 exec_lo, 0x00ffffff
  s_mov_b32 exec_hi, 0x00ffffff
  ds_write_b128 v68, v[44:47] offset:512
  s_mov_b64 exec, -1
  s_mul_i32 s44, s3, 7168
  s_lshl_b32 s45, s14, 10
  s_add_u32 s44, s44, s45
  s_waitcnt lgkmcnt(0)
  s_barrier
  ds_read_b64_tr_b16 v[72:73], v69
  ds_read_b64_tr_b16 v[74:75], v69 offset:3840
  ds_read_b64_tr_b16 v[76:77], v69 offset:512
  ds_read_b64_tr_b16 v[78:79], v69 offset:4352
  s_waitcnt lgkmcnt(2)
  buffer_store_dwordx4 v[72:75], v70, s[20:23], s44 offen sc1
  s_cmp_eq_u32 s14, 3
  s_cbranch_scc1 L_ln89
  s_add_u32 s44, s44, 4096
  s_waitcnt lgkmcnt(0)
  buffer_store_dwordx4 v[76:79], v70, s[20:23], s44 offen sc1
L_ln89:
  s_waitcnt lgkmcnt(0)
  s_waitcnt vmcnt(2)
  v_readfirstlane_b32 s48, v191
  v_lshlrev_b32 v14, 16, v14
  v_mul_f32 v15, 0x3fb8aa3b, v14
  s_mov_b32 s34, 0x3fb8aa3b
  v_fma_f32 v16, v14, s34, -v15
  s_mov_b32 s34, 0x32a57060
  v_fma_f32 v16, v14, s34, v16
  v_exp_f32 v15, v15
  v_mul_f32 v16, 0x3f317218, v16
  v_fma_f32 v15, v15, v16, v15
  v_cvt_pk_bf16_f32 v15, v15, v15
  v_lshlrev_b32 v15, 16, v15
  s_cmp_lg_u32 s48, 0
  s_cbranch_scc1 L_s_haven
  v_mov_b32 v104, 0
  s_mov_b32 s49, 0
L_nonce10:
  buffer_load_dword v105, v104, s[52:55], 0 offen sc1
  s_waitcnt vmcnt(0)
  v_readfirstlane_b32 s48, v105
  s_nop 3
  s_cmp_lg_u32 s48, 0
  s_cbranch_scc1 L_nonce_e11
  s_add_u32 s49, s49, 1
  s_cmp_lt_u32 s49, 200000
  s_sleep 1
  s_cbranch_scc1 L_nonce10
L_nonce_e11:
L_s_haven:
  s_lshl_b32 s30, s3, 4
  s_waitcnt vmcnt(0)
  s_barrier
  v_cmp_eq_u32 vcc, 0, v0
  s_nop 0
  s_and_saveexec_b64 s[44:45], vcc
  s_add_u32 s30, s30, 0
  v_mov_b32 v104, s30
  v_mov_b32 v105, s48
  buffer_store_dword v105, v104, s[36:39], 0 offen sc1
  s_mov_b64 exec, s[44:45]
  s_setprio 0
  s_mov_b32 s35, 0
  s_mov_b32 s34, 16
L_s_item:
  v_lshlrev_b32 v51, s34, v9
  v_lshlrev_b32 v50, s34, v8
  v_and_b32 v51, 0xffff0000, v51
  v_and_b32 v50, 0xffff0000, v50
  v_mul_f32 v19, v15, v51
  v_mul_f32 v18, v15, v50
  v_mul_f32 v19, 0.15915494, v19
  v_lshlrev_b32 v52, s34, v10
  v_mul_f32 v18, 0x3fb8aa3b, v18
  v_mul_f32 v69, 1.0, v19
  v_mul_f32 v71, 0x43800000, v19
  v_and_b32 v52, 0xffff0000, v52
  v_lshlrev_b32 v53, s34, v11
  v_lshlrev_b32 v55, s34, v13
  v_mul_f32 v68, 1.0, v18
  v_fract_f32 v69, v69
  v_mul_f32 v70, 0x43800000, v18
  v_fract_f32 v71, v71
  v_mul_f32 v79, 0x41c00000, v19
  v_and_b32 v53, 0xffff0000, v53
  v_lshlrev_b32 v54, s34, v12
  v_and_b32 v55, 0xffff0000, v55
  v_mul_f32 v52, v15, v52
  v_exp_f32 v68, v68
  v_sin_f32 v21, v69
  v_exp_f32 v70, v70
  v_cos_f32 v26, v71
  v_cos_f32 v20, v69
  v_mul_f32 v73, 0x42000000, v19
  v_mul_f32 v78, 0x41c00000, v18
  v_fract_f32 v79, v79
  v_and_b32 v54, 0xffff0000, v54
  v_mul_f32 v53, v15, v53
  v_mul_f32 v67, v55, v52
  v_sin_f32 v27, v71
  v_mul_f32 v77, 0x41800000, v19
  v_mul_f32 v72, 0x42000000, v18
  v_fract_f32 v73, v73
  v_mul_f32 v75, 0x41000000, v19
  v_exp_f32 v78, v78
  v_cos_f32 v34, v79
  v_sin_f32 v35, v79
  v_mul_f32 v66, v55, v53
  v_fma_f32 v17, v54, v53, v67
  v_mul_f32 v21, v21, v68
  v_mul_f32 v26, v26, v70
  v_mul_f32 v76, 0x41800000, v18
  v_fract_f32 v77, v77
  v_mul_f32 v20, v20, v68
  v_exp_f32 v72, v72
  v_cos_f32 v36, v73
  v_mul_f32 v74, 0x41000000, v18
  v_fract_f32 v75, v75
  v_fma_f32 v16, v54, v52, -v66
  v_mul_f32 v27, v27, v70
  v_sin_f32 v37, v73
  v_exp_f32 v76, v76
  v_sin_f32 v33, v77
  v_mul_f32 v64, v21, v21
  v_mul_f32 v79, v17, v26
  v_exp_f32 v74, v74
  v_cos_f32 v30, v75
  v_sin_f32 v31, v75
  v_cos_f32 v32, v77
  v_mul_f32 v34, v34, v78
  v_mul_f32 v35, v35, v78
  v_mul_f32 v65, v21, v20
  v_fma_f32 v22, v20, v20, -v64
  v_mul_f32 v78, v17, v27
  v_fma_f32 v43, v16, v27, v79
  v_mul_f32 v36, v36, v72
  v_fma_f32 v23, v20, v21, v65
  v_mul_f32 v37, v37, v72
  v_mul_f32 v33, v33, v76
  v_mul_f32 v77, v17, v20
  v_fma_f32 v42, v16, v26, -v78
  v_mul_f32 v65, v43, v22
  v_mul_f32 v30, v30, v74
  v_mul_f32 v31, v31, v74
  v_mul_f32 v32, v32, v76
  v_mov_b32 v29, 0
  v_mul_f32 v75, v35, v36
  v_cvt_pk_bf16_f32 v181, v33, v35
  v_mul_f32 v73, v33, v36
  v_mul_f32 v74, v35, v37
  v_mul_f32 v76, v17, v21
  v_fma_f32 v41, v16, v21, v77
  v_mul_f32 v64, v43, v23
  v_fma_f32 v47, v42, v23, v65
  v_mov_b32 v28, 1.0
  v_mul_f32 v69, v29, v36
  v_mul_f32 v71, v31, v36
  v_mul_f32 v72, v33, v37
  v_fma_f32 v35, v34, v37, v75
  v_mul_f32 v67, v23, v22
  v_cvt_pk_bf16_f32 v177, v32, v34
  v_cvt_pk_bf16_f32 v180, v29, v31
  v_mul_f32 v68, v29, v37
  v_mul_f32 v70, v31, v37
  v_fma_f32 v33, v32, v37, v73
  v_fma_f32 v40, v16, v20, -v76
  v_fma_f32 v46, v42, v22, -v64
  v_mul_f32 v75, v41, v20
  v_mul_f32 v79, v47, v22
  v_mul_f32 v66, v23, v23
  v_cvt_pk_bf16_f32 v176, v28, v30
  v_fma_f32 v29, v28, v37, v69
  v_fma_f32 v31, v30, v37, v71
  v_fma_f32 v32, v32, v36, -v72
  v_fma_f32 v34, v34, v36, -v74
  v_mul_f32 v73, v35, v36
  v_fma_f32 v25, v22, v23, v67
  v_fma_f32 v30, v30, v36, -v70
  v_cvt_pk_bf16_f32 v183, v33, v35
  v_mul_f32 v71, v33, v36
  v_mul_f32 v72, v35, v37
  v_mul_f32 v74, v41, v21
  v_fma_f32 v39, v40, v21, v75
  v_mul_f32 v77, v43, v26
  v_mul_f32 v78, v47, v23
  v_fma_f32 v49, v46, v23, v79
  v_fma_f32 v24, v22, v22, -v66
  v_fma_f32 v28, v28, v36, -v68
  v_mul_f32 v67, v29, v36
  v_mul_f32 v69, v31, v36
  v_mul_f32 v70, v33, v37
  v_fma_f32 v35, v34, v37, v73
  v_cvt_pk_bf16_f32 v179, v32, v34
  v_cvt_pk_bf16_f32 v182, v29, v31
  v_mul_f32 v66, v29, v37
  v_mul_f32 v68, v31, v37
  v_fma_f32 v33, v32, v37, v71
  v_fma_f32 v38, v40, v20, -v74
  v_mul_f32 v76, v43, v27
  v_fma_f32 v45, v42, v27, v77
  v_fma_f32 v48, v46, v22, -v78
  v_mul_f32 v73, v39, v20
  v_mul_f32 v75, v49, v22
  v_cvt_pk_bf16_f32 v84, -v17, -v41
  v_cvt_pk_bf16_f32 v92, -v43, -v47
  v_fma_f32 v29, v28, v37, v67
  v_fma_f32 v31, v30, v37, v69
  v_fma_f32 v32, v32, v36, -v70
  v_fma_f32 v34, v34, v36, -v72
  v_mul_f32 v71, v35, v36
  v_cvt_pk_bf16_f32 v178, v28, v30
  v_cvt_pk_bf16_f32 v189, v33, v35
  v_fma_f32 v44, v42, v26, -v76
  v_mul_f32 v70, v35, v37
  v_mul_f32 v72, v39, v21
  v_fma_f32 v41, v38, v21, v73
  v_mul_f32 v74, v49, v23
  v_fma_f32 v47, v48, v23, v75
  v_mul_f32 v77, v45, v26
  v_cvt_pk_bf16_f32 v80, v16, v40
  v_cvt_pk_bf16_f32 v88, v42, v46
  v_fma_f32 v28, v28, v36, -v66
  v_fma_f32 v30, v30, v36, -v68
  v_mul_f32 v65, v29, v36
  v_mul_f32 v67, v31, v36
  v_mul_f32 v69, v33, v36
  v_fma_f32 v35, v34, v37, v71
  v_mul_f32 v73, v45, v24
  v_cvt_pk_bf16_f32 v185, v32, v34
  v_cvt_pk_bf16_f32 v188, v29, v31
  v_mul_f32 v64, v29, v37
  v_mul_f32 v66, v31, v37
  v_mul_f32 v68, v33, v37
  v_fma_f32 v40, v38, v20, -v72
  v_fma_f32 v46, v48, v22, -v74
  v_cvt_pk_bf16_f32 v93, -v49, -v47
  v_mul_f32 v76, v45, v27
  v_fma_f32 v43, v44, v27, v77
  v_mul_f32 v71, v41, v20
  v_fma_f32 v29, v28, v37, v65
  v_fma_f32 v31, v30, v37, v67
  v_fma_f32 v33, v32, v37, v69
  v_fma_f32 v34, v34, v36, -v70
  v_cvt_pk_bf16_f32 v85, -v39, -v41
  v_mul_f32 v72, v45, v25
  v_fma_f32 v49, v44, v25, v73
  v_cvt_pk_bf16_f32 v184, v28, v30
  v_cvt_pk_bf16_f32 v89, v48, v46
  v_fma_f32 v42, v44, v26, -v76
  v_mul_f32 v70, v41, v21
  v_fma_f32 v39, v40, v21, v71
  v_mul_f32 v75, v43, v26
  v_fma_f32 v28, v28, v36, -v64
  v_fma_f32 v30, v30, v36, -v66
  v_fma_f32 v32, v32, v36, -v68
  v_cvt_pk_bf16_f32 v81, v38, v40
  v_mul_f32 v79, v29, v36
  v_mul_f32 v65, v31, v36
  v_mul_f32 v67, v33, v36
  v_mul_f32 v69, v35, v36
  v_fma_f32 v48, v44, v24, -v72
  v_cvt_pk_bf16_f32 v94, -v45, -v49
  v_mul_f32 v71, v43, v24
  v_cvt_pk_bf16_f32 v190, v29, v31
  v_cvt_pk_bf16_f32 v191, v33, v35
  v_mul_f32 v78, v29, v37
  v_mul_f32 v64, v31, v37
  v_mul_f32 v66, v33, v37
  v_mul_f32 v68, v35, v37
  v_fma_f32 v38, v40, v20, -v70
  v_mul_f32 v74, v43, v27
  v_fma_f32 v45, v42, v27, v75
  v_fma_f32 v29, v28, v37, v79
  v_fma_f32 v31, v30, v37, v65
  v_fma_f32 v33, v32, v37, v67
  v_fma_f32 v35, v34, v37, v69
  v_cvt_pk_bf16_f32 v90, v44, v48
  v_mul_f32 v70, v43, v25
  v_fma_f32 v47, v42, v25, v71
  ds_write_b128 v144, v[176:179] offset:8192
  v_cvt_pk_bf16_f32 v186, v28, v30
  v_cvt_pk_bf16_f32 v187, v32, v34
  v_fma_f32 v44, v42, v26, -v74
  v_mul_f32 v73, v45, v26
  ds_write_b128 v148, v[180:183] offset:8192
  v_fma_f32 v28, v28, v36, -v78
  v_fma_f32 v30, v30, v36, -v64
  v_fma_f32 v32, v32, v36, -v66
  v_fma_f32 v34, v34, v36, -v68
  v_mul_f32 v77, v29, v36
  v_mul_f32 v79, v31, v36
  v_mul_f32 v65, v33, v36
  v_mul_f32 v67, v35, v36
  v_mul_f32 v69, v39, v20
  v_fma_f32 v46, v42, v24, -v70
  v_cvt_pk_bf16_f32 v95, -v43, -v47
  v_cvt_pk_bf16_f32 v180, v29, v31
  v_cvt_pk_bf16_f32 v181, v33, v35
  v_mul_f32 v76, v29, v37
  v_mul_f32 v78, v31, v37
  v_mul_f32 v64, v33, v37
  v_mul_f32 v66, v35, v37
  v_mul_f32 v72, v45, v27
  v_fma_f32 v43, v44, v27, v73
  v_fma_f32 v29, v28, v37, v77
  v_fma_f32 v31, v30, v37, v79
  v_fma_f32 v33, v32, v37, v65
  v_fma_f32 v35, v34, v37, v67
  v_mul_f32 v68, v39, v21
  v_fma_f32 v41, v38, v21, v69
  v_cvt_pk_bf16_f32 v91, v42, v46
  v_cvt_pk_bf16_f32 v176, v28, v30
  v_cvt_pk_bf16_f32 v177, v32, v34
  v_fma_f32 v42, v44, v26, -v72
  v_mul_f32 v69, v43, v26
  v_fma_f32 v28, v28, v36, -v76
  v_fma_f32 v30, v30, v36, -v78
  v_fma_f32 v32, v32, v36, -v64
  v_fma_f32 v34, v34, v36, -v66
  v_fma_f32 v40, v38, v20, -v68
  v_cvt_pk_bf16_f32 v100, -v45, -v43
  v_mul_f32 v75, v29, v36
  v_mul_f32 v77, v31, v36
  v_mul_f32 v79, v33, v36
  v_mul_f32 v65, v35, v36
  v_cvt_pk_bf16_f32 v182, v29, v31
  v_cvt_pk_bf16_f32 v183, v33, v35
  v_mul_f32 v74, v29, v37
  v_mul_f32 v76, v31, v37
  v_mul_f32 v78, v33, v37
  v_mul_f32 v64, v35, v37
  v_mul_f32 v68, v43, v27
  v_fma_f32 v45, v42, v27, v69
  v_cvt_pk_bf16_f32 v96, v44, v42
  v_fma_f32 v29, v28, v37, v75
  v_fma_f32 v31, v30, v37, v77
  v_fma_f32 v33, v32, v37, v79
  v_fma_f32 v35, v34, v37, v65
  ds_write_b128 v145, v[184:187] offset:8192
  v_cvt_pk_bf16_f32 v178, v28, v30
  v_cvt_pk_bf16_f32 v179, v32, v34
  v_fma_f32 v44, v42, v26, -v68
  v_mul_f32 v71, v45, v26
  ds_write_b128 v149, v[188:191] offset:8192
  v_fma_f32 v28, v28, v36, -v74
  v_fma_f32 v30, v30, v36, -v76
  v_fma_f32 v32, v32, v36, -v78
  v_fma_f32 v34, v34, v36, -v64
  v_mul_f32 v66, v41, v21
  v_mul_f32 v70, v45, v27
  v_mul_f32 v73, v29, v36
  v_mul_f32 v75, v31, v36
  v_mul_f32 v77, v33, v36
  v_mul_f32 v79, v35, v36
  v_cvt_pk_bf16_f32 v82, v38, v40
  v_cvt_pk_bf16_f32 v188, v29, v31
  v_cvt_pk_bf16_f32 v189, v33, v35
  v_mul_f32 v67, v41, v20
  v_fma_f32 v43, v44, v27, v71
  v_mul_f32 v72, v29, v37
  v_mul_f32 v74, v31, v37
  v_mul_f32 v76, v33, v37
  v_mul_f32 v78, v35, v37
  v_cvt_pk_bf16_f32 v86, -v39, -v41
  v_cvt_pk_bf16_f32 v184, v28, v30
  v_cvt_pk_bf16_f32 v185, v32, v34
  v_fma_f32 v38, v40, v20, -v66
  v_fma_f32 v42, v44, v26, -v70
  v_fma_f32 v29, v28, v37, v73
  v_fma_f32 v31, v30, v37, v75
  v_fma_f32 v33, v32, v37, v77
  v_fma_f32 v35, v34, v37, v79
  v_fma_f32 v39, v40, v21, v67
  v_fma_f32 v28, v28, v36, -v72
  v_fma_f32 v30, v30, v36, -v74
  v_fma_f32 v32, v32, v36, -v76
  v_fma_f32 v34, v34, v36, -v78
  v_mul_f32 v66, v43, v27
  ds_write_b128 v146, v[176:179] offset:8192
  v_cvt_pk_bf16_f32 v97, v44, v42
  v_mul_f32 v67, v43, v26
  ds_write_b128 v150, v[180:183] offset:8192
  v_cvt_pk_bf16_f32 v101, -v45, -v43
  v_cvt_pk_bf16_f32 v186, v28, v30
  v_cvt_pk_bf16_f32 v187, v32, v34
  v_mul_f32 v64, v39, v21
  v_fma_f32 v44, v42, v26, -v66
  ds_write_b128 v145, v[88:91]
  v_cvt_pk_bf16_f32 v190, v29, v31
  v_cvt_pk_bf16_f32 v191, v33, v35
  v_mul_f32 v65, v39, v20
  v_fma_f32 v45, v42, v27, v67
  ds_write_b128 v149, v[92:95]
  v_fma_f32 v40, v38, v20, -v64
  v_cvt_pk_bf16_f32 v98, v44, 0
  ds_write_b128 v147, v[184:187] offset:8192
  v_fma_f32 v41, v38, v21, v65
  v_cvt_pk_bf16_f32 v102, -v45, 0
  v_mov_b32 v99, 0
  ds_write_b128 v151, v[188:191] offset:8192
  v_cvt_pk_bf16_f32 v83, v38, v40
  v_mov_b32 v103, 0
  v_cvt_pk_bf16_f32 v87, -v39, -v41
  ds_write_b128 v146, v[96:99]
  ds_write_b128 v150, v[100:103]
  ds_write_b128 v144, v[80:83]
  ds_write_b128 v148, v[84:87]
  s_waitcnt lgkmcnt(0)
  ds_read_b64_tr_b16 v[64:65], v152 offset:0
  ds_read_b64_tr_b16 v[66:67], v153 offset:0
  ds_read_b64_tr_b16 v[68:69], v152 offset:8192
  ds_read_b64_tr_b16 v[70:71], v153 offset:8192
  ds_read_b64_tr_b16 v[72:73], v152 offset:1024
  ds_read_b64_tr_b16 v[74:75], v153 offset:1024
  ds_read_b64_tr_b16 v[76:77], v152 offset:9216
  ds_read_b64_tr_b16 v[78:79], v153 offset:9216
  ds_read_b64_tr_b16 v[80:81], v152 offset:2048
  ds_read_b64_tr_b16 v[82:83], v153 offset:2048
  ds_read_b64_tr_b16 v[84:85], v152 offset:10240
  ds_read_b64_tr_b16 v[86:87], v153 offset:10240
  ds_read_b64_tr_b16 v[88:89], v152 offset:3072
  ds_read_b64_tr_b16 v[90:91], v153 offset:3072
  ds_read_b64_tr_b16 v[92:93], v152 offset:11264
  ds_read_b64_tr_b16 v[94:95], v153 offset:11264
  s_waitcnt lgkmcnt(12)
  v_mfma_f32_32x32x16_bf16 v[112:127], v[64:67], v[68:71], v[112:127]
  s_waitcnt lgkmcnt(8)
  v_mfma_f32_32x32x16_bf16 v[112:127], v[72:75], v[76:79], v[112:127]
  s_waitcnt lgkmcnt(4)
  v_mfma_f32_32x32x16_bf16 v[112:127], v[80:83], v[84:87], v[112:127]
  s_waitcnt lgkmcnt(0)
  v_mfma_f32_32x32x16_bf16 v[112:127], v[88:91], v[92:95], v[112:127]
  ds_read_b64_tr_b16 v[64:65], v152 offset:4096
  ds_read_b64_tr_b16 v[66:67], v153 offset:4096
  ds_read_b64_tr_b16 v[68:69], v152 offset:12288
  ds_read_b64_tr_b16 v[70:71], v153 offset:12288
  ds_read_b64_tr_b16 v[72:73], v152 offset:5120
  ds_read_b64_tr_b16 v[74:75], v153 offset:5120
  ds_read_b64_tr_b16 v[76:77], v152 offset:13312
  ds_read_b64_tr_b16 v[78:79], v153 offset:13312
  ds_read_b64_tr_b16 v[80:81], v152 offset:6144
  ds_read_b64_tr_b16 v[82:83], v153 offset:6144
  ds_read_b64_tr_b16 v[84:85], v152 offset:14336
  ds_read_b64_tr_b16 v[86:87], v153 offset:14336
  ds_read_b64_tr_b16 v[88:89], v152 offset:7168
  ds_read_b64_tr_b16 v[90:91], v153 offset:7168
  ds_read_b64_tr_b16 v[92:93], v152 offset:15360
  ds_read_b64_tr_b16 v[94:95], v153 offset:15360
  s_waitcnt lgkmcnt(12)
  v_mfma_f32_32x32x16_bf16 v[112:127], v[64:67], v[68:71], v[112:127]
  s_waitcnt lgkmcnt(8)
  v_mfma_f32_32x32x16_bf16 v[112:127], v[72:75], v[76:79], v[112:127]
  s_waitcnt lgkmcnt(4)
  v_mfma_f32_32x32x16_bf16 v[112:127], v[80:83], v[84:87], v[112:127]
  s_waitcnt lgkmcnt(0)
  v_mfma_f32_32x32x16_bf16 v[112:127], v[88:91], v[92:95], v[112:127]
  s_cmp_lg_u32 s35, 0
  s_cbranch_scc1 L_s_nou
  s_setprio 3
  buffer_load_dword v104, v156, s[36:39], 0 offen offset:0 sc1
  buffer_load_dword v105, v156, s[36:39], 0 offen offset:1024 sc1
  buffer_load_dword v106, v156, s[36:39], 0 offen offset:2048 sc1
  buffer_load_dword v107, v156, s[36:39], 0 offen offset:3072 sc1
  s_setprio 0
L_s_nou:
  s_mov_b32 s34, 0
  s_add_u32 s35, s35, 1
  s_cmp_lt_u32 s35, 2
  s_cbranch_scc1 L_s_item
  s_setprio 2
  s_waitcnt vmcnt(0)
  v_xor_b32 v104, s48, v104
  v_xor_b32 v105, s48, v105
  v_xor_b32 v106, s48, v106
  v_xor_b32 v107, s48, v107
  v_or_b32 v104, v104, v105
  v_or_b32 v106, v106, v107
  v_or_b32 v104, v104, v106
  v_cmp_ne_u32 vcc, 0, v104
  s_nop 4
  s_cbranch_vccz L_s_haveu
  s_mov_b32 s45, 0
  s_cmp_lg_u32 s45, 0
  s_cbranch_scc1 L_wf_e13
  v_and_b32 v90, 63, v0
  v_min_u32 v90, 63, v90
  v_lshlrev_b32 v90, 4, v90
  v_add_u32 v90, 0, v90
  v_and_b32 v92, 63, v0
  v_min_u32 v92, 63, v92
  v_lshlrev_b32 v92, 4, v92
  v_add_u32 v92, 1024, v92
  v_and_b32 v94, 63, v0
  v_min_u32 v94, 63, v94
  v_lshlrev_b32 v94, 4, v94
  v_add_u32 v94, 2048, v94
  v_and_b32 v96, 63, v0
  v_min_u32 v96, 63, v96
  v_lshlrev_b32 v96, 4, v96
  v_add_u32 v96, 3072, v96
  s_mov_b32 s49, 0
L_wf12:
  buffer_load_dword v91, v90, s[36:39], 0 offen sc1
  buffer_load_dword v93, v92, s[36:39], 0 offen sc1
  buffer_load_dword v95, v94, s[36:39], 0 offen sc1
  buffer_load_dword v97, v96, s[36:39], 0 offen sc1
  s_waitcnt vmcnt(0)
  v_xor_b32 v93, s48, v93
  v_xor_b32 v95, s48, v95
  v_xor_b32 v97, s48, v97
  v_xor_b32 v91, s48, v91
  v_or_b32 v91, v91, v93
  v_or_b32 v91, v91, v95
  v_or_b32 v91, v91, v97
  v_cmp_ne_u32 vcc, 0, v91
  s_nop 4
  s_cbranch_vccz L_wf_e13
  s_add_u32 s49, s49, 1
  s_cmp_lt_u32 s49, 200000
  s_sleep 1
  s_cbranch_scc1 L_wf12
L_wf_e13:
L_s_haveu:
  buffer_load_dwordx4 v[104:107], v157, s[20:23], 0 offen sc1
  buffer_load_dwordx4 v[108:111], v158, s[20:23], 0 offen sc1
  s_mul_i32 s30, s15, 3072
  s_add_u32 s30, s30, 65536
  v_add_u32 v4, s30, v3
  s_cmp_eq_u32 s28, 0
  s_cbranch_scc1 L_kg_a
  s_nop 7
  s_nop 3
  ds_write_b128 v4, v[112:115] offset:0
  ds_write_b128 v4, v[116:119] offset:1024
  ds_write_b128 v4, v[120:123] offset:2048
  s_waitcnt lgkmcnt(0)
L_kg_a:
  s_barrier
  s_cmp_eq_u32 s28, 0
  s_cbranch_scc0 L_kg_b
  ds_read_b128 v[64:67], v4 offset:0
  ds_read_b128 v[68:71], v4 offset:1024
  ds_read_b128 v[72:75], v4 offset:2048
  v_and_b32 v6, 31, v1
  v_lshrrev_b32 v12, 5, v1
  v_lshlrev_b32 v8, 4, v6
  v_lshl_add_u32 v8, v12, 3, v8
  v_add_u32 v8, s31, v8
  v_lshlrev_b32 v9, 3, v6
  v_add_u32 v9, s31, v9
  v_lshlrev_b32 v10, 2, v6
  v_add_u32 v10, s31, v10
  v_lshlrev_b32 v11, 1, v6
  v_add_u32 v11, s31, v11
  s_waitcnt lgkmcnt(0)
  v_add_f32 v112, v112, v64
  v_add_f32 v113, v113, v65
  v_add_f32 v114, v114, v66
  v_add_f32 v115, v115, v67
  v_add_f32 v116, v116, v68
  v_add_f32 v117, v117, v69
  v_add_f32 v118, v118, v70
  v_add_f32 v119, v119, v71
  v_add_f32 v120, v120, v72
  v_add_f32 v121, v121, v73
  v_add_f32 v122, v122, v74
  v_add_f32 v123, v123, v75
  v_cvt_pk_bf16_f32 v80, v112, v113
  v_cvt_pk_bf16_f32 v81, v114, v115
  v_cvt_pk_bf16_f32 v82, v116, v117
  v_cvt_pk_bf16_f32 v83, v118, v119
  v_cvt_pk_bf16_f32 v84, v120, v121
  v_cvt_pk_bf16_f32 v85, v122, v123
  ds_write_b64 v8, v[80:81]
  s_mov_b64 s[40:41], exec
  s_mov_b32 exec_lo, -1
  s_mov_b32 exec_hi, 0
  ds_write_b64 v9, v[82:83] offset:512
  ds_write_b16 v11, v84 offset:1024
  ds_write_b16_d16_hi v11, v84 offset:1088
  ds_write_b16 v11, v85 offset:1152
  ds_write_b16_d16_hi v11, v85 offset:1216
  s_mov_b32 exec_lo, 0
  s_mov_b32 exec_hi, -1
  ds_write_b32 v10, v82 offset:768
  ds_write_b32 v10, v83 offset:896
  ds_write_b16 v11, v84 offset:1280
  s_mov_b64 exec, s[40:41]
  s_waitcnt lgkmcnt(0)
L_kg_b:
  s_mul_i32 s33, s15, 37888
  s_add_u32 s34, s33, 33280
  s_barrier
  ds_read_u16 v64, v160
  ds_read_u16_d16_hi v80, v161
  ds_read_u16 v65, v162
  ds_read_u16_d16_hi v81, v163
  ds_read_u16 v66, v164
  ds_read_u16_d16_hi v82, v165
  ds_read_u16 v67, v166
  ds_read_u16_d16_hi v83, v167
  ds_read_u16 v72, v168
  ds_read_u16_d16_hi v84, v169
  ds_read_u16 v73, v170
  ds_read_u16_d16_hi v85, v171
  ds_read_u16 v74, v172
  ds_read_u16_d16_hi v86, v173
  ds_read_u16 v75, v174
  ds_read_u16_d16_hi v87, v175
  v_mov_b32 v28, 0
  v_mov_b32 v29, 0
  v_mov_b32 v30, 0
  v_mov_b32 v31, 0
  v_add_u32 v25, s34, v3
  v_subrev_u32 v26, 32, v1
  v_mul_u32_u24 v26, 4160, v26
  v_add_u32 v26, s33, v26
  v_add_u32 v26, 4096, v26
  v_cmp_gt_u32 vcc, 32, v1
  s_nop 1
  v_cndmask_b32 v25, v26, v25, vcc
  v_lshlrev_b32 v27, 4, v2
  v_add_u32 v27, s33, v27
  s_waitcnt lgkmcnt(0)
  v_and_b32 v80, 0xffff0000, v80
  v_or_b32 v64, v64, v80
  v_and_b32 v81, 0xffff0000, v81
  v_or_b32 v65, v65, v81
  v_and_b32 v82, 0xffff0000, v82
  v_or_b32 v66, v66, v82
  v_and_b32 v83, 0xffff0000, v83
  v_or_b32 v67, v67, v83
  v_and_b32 v84, 0xffff0000, v84
  v_or_b32 v72, v72, v84
  v_and_b32 v85, 0xffff0000, v85
  v_or_b32 v73, v73, v85
  v_and_b32 v86, 0xffff0000, v86
  v_or_b32 v74, v74, v86
  v_and_b32 v87, 0xffff0000, v87
  v_or_b32 v75, v75, v87
  ds_write_b128 v27, v[64:67]
  ds_write_b128 v27, v[72:75] offset:2048
  v_cmp_gt_u32 vcc, 40, v1
  s_nop 0
  s_and_saveexec_b64 s[40:41], vcc
  ds_write_b128 v25, v[28:31]
  s_mov_b64 exec, s[40:41]
  s_waitcnt lgkmcnt(0)
  s_barrier
  ds_read_b128 v[68:71], v27 offset:16
  ds_read_b128 v[76:79], v27 offset:2064
  v_lshlrev_b32 v10, 4, v2
  v_add_u32 v10, s34, v10
  s_waitcnt vmcnt(0)
  ds_write_b128 v10, v[104:107] offset:512
  ds_write_b128 v10, v[108:111] offset:2560
  s_waitcnt lgkmcnt(2)
  v_alignbit_b32 v96, v65, v64, 16
  v_alignbit_b32 v97, v66, v65, 16
  v_alignbit_b32 v98, v67, v66, 16
  v_alignbit_b32 v99, v68, v67, 16
  v_mov_b32 v112, v65
  v_mov_b32 v113, v66
  v_mov_b32 v114, v67
  v_mov_b32 v115, v68
  v_alignbit_b32 v104, v66, v65, 16
  v_alignbit_b32 v105, v67, v66, 16
  v_alignbit_b32 v106, v68, v67, 16
  v_alignbit_b32 v107, v69, v68, 16
  ds_write_b128 v27, v[96:99] offset:4160
  ds_write_b128 v27, v[112:115] offset:8320
  v_alignbit_b32 v100, v69, v68, 16
  v_alignbit_b32 v101, v70, v69, 16
  ds_write_b128 v27, v[104:107] offset:12480
  v_mov_b32 v116, v69
  v_mov_b32 v117, v70
  ds_write_b128 v27, v[66:69] offset:16640
  v_alignbit_b32 v108, v70, v69, 16
  v_alignbit_b32 v109, v71, v70, 16
  ds_write_b128 v27, v[98:101] offset:20800
  ds_write_b128 v27, v[114:117] offset:24960
  v_alignbit_b32 v102, v71, v70, 16
  ds_write_b128 v27, v[106:109] offset:29120
  v_alignbit_b32 v120, v73, v72, 16
  v_alignbit_b32 v121, v74, v73, 16
  v_alignbit_b32 v122, v75, v74, 16
  v_alignbit_b32 v123, v76, v75, 16
  v_mov_b32 v136, v73
  v_mov_b32 v137, v74
  v_mov_b32 v138, v75
  v_mov_b32 v139, v76
  v_alignbit_b32 v128, v74, v73, 16
  v_alignbit_b32 v129, v75, v74, 16
  v_alignbit_b32 v130, v76, v75, 16
  v_alignbit_b32 v131, v77, v76, 16
  ds_write_b128 v27, v[120:123] offset:6208
  ds_write_b128 v27, v[136:139] offset:10368
  v_alignbit_b32 v124, v77, v76, 16
  v_alignbit_b32 v125, v78, v77, 16
  ds_write_b128 v27, v[128:131] offset:14528
  v_mov_b32 v140, v77
  v_mov_b32 v141, v78
  ds_write_b128 v27, v[74:77] offset:18688
  v_alignbit_b32 v132, v78, v77, 16
  v_alignbit_b32 v133, v79, v78, 16
  ds_write_b128 v27, v[122:125] offset:22848
  ds_write_b128 v27, v[138:141] offset:27008
  v_alignbit_b32 v126, v79, v78, 16
  ds_write_b128 v27, v[130:133] offset:31168
  v_bfe_u32 v11, v1, 3, 1
  v_bfe_u32 v12, v1, 5, 1
  v_and_b32 v10, 7, v1
  v_bfe_u32 v13, v1, 4, 1
  v_lshl_add_u32 v14, v12, 1, v11
  v_and_b32 v15, 15, v1
  v_sub_u32 v10, 7, v10
  v_sub_u32 v14, v13, v14
  v_sub_u32 v15, v15, v12
  s_add_u32 s30, s33, 496
  v_mul_u32_u24 v10, 4160, v10
  v_lshlrev_b32 v14, 4, v14
  s_lshl_b32 s31, s28, 8
  v_lshlrev_b32 v15, 5, v15
  s_sub_u32 s30, s30, s31
  v_add_u32 v10, v10, v14
  v_lshl_add_u32 v15, v13, 4, v15
  s_add_u32 s32, s34, 512
  s_sub_u32 s32, s32, s31
  v_add_u32 v4, s30, v10
  v_add_u32 v5, s32, v15
  v_mov_b32 v32, 0
  v_mov_b32 v33, 0
  v_mov_b32 v34, 0
  v_mov_b32 v35, 0
  v_mov_b32 v36, 0
  v_mov_b32 v37, 0
  v_mov_b32 v38, 0
  v_mov_b32 v39, 0
  v_mov_b32 v40, 0
  v_mov_b32 v41, 0
  v_mov_b32 v42, 0
  v_mov_b32 v43, 0
  v_mov_b32 v44, 0
  v_mov_b32 v45, 0
  v_mov_b32 v46, 0
  v_mov_b32 v47, 0
  v_mov_b32 v48, 0
  v_mov_b32 v49, 0
  v_mov_b32 v50, 0
  v_mov_b32 v51, 0
  v_mov_b32 v52, 0
  v_mov_b32 v53, 0
  v_mov_b32 v54, 0
  v_mov_b32 v55, 0
  v_mov_b32 v56, 0
  v_mov_b32 v57, 0
  v_mov_b32 v58, 0
  v_mov_b32 v59, 0
  v_mov_b32 v60, 0
  v_mov_b32 v61, 0
  v_mov_b32 v62, 0
  v_mov_b32 v63, 0
  s_waitcnt lgkmcnt(0)
  s_barrier
  ds_read_b128 v[64:67], v4 offset:3584
  ds_read_b128 v[96:99], v5 offset:0
  ds_read_b128 v[68:71], v4 offset:3072
  ds_read_b128 v[100:103], v5 offset:512
  ds_read_b128 v[72:75], v4 offset:2560
  ds_read_b128 v[104:107], v5 offset:1024
  ds_read_b128 v[76:79], v4 offset:2048
  ds_read_b128 v[108:111], v5 offset:1536
  ds_read_b128 v[80:83], v4 offset:1536
  ds_read_b128 v[112:115], v5 offset:2048
  ds_read_b128 v[84:87], v4 offset:1024
  ds_read_b128 v[116:119], v5 offset:2560
  ds_read_b128 v[88:91], v4 offset:512
  ds_read_b128 v[120:123], v5 offset:3072
  ds_read_b128 v[92:95], v4 offset:0
  ds_read_b128 v[124:127], v5 offset:3584
  v_subrev_u32 v4, 64, v4
  v_subrev_u32 v5, 64, v5
  s_mov_b32 s35, 0
L_cv_loop:
  s_waitcnt lgkmcnt(0)
  v_mfma_f32_16x16x32_bf16 v[32:35], v[64:67], v[96:99], v[32:35]
  v_mfma_f32_16x16x32_bf16 v[36:39], v[64:67], v[100:103], v[36:39]
  v_mfma_f32_16x16x32_bf16 v[40:43], v[64:67], v[104:107], v[40:43]
  v_mfma_f32_16x16x32_bf16 v[44:47], v[64:67], v[108:111], v[44:47]
  ds_read_b128 v[128:131], v4 offset:3584
  ds_read_b128 v[160:163], v5 offset:0
  v_mfma_f32_16x16x32_bf16 v[48:51], v[64:67], v[112:115], v[48:51]
  v_mfma_f32_16x16x32_bf16 v[52:55], v[64:67], v[116:119], v[52:55]
  v_mfma_f32_16x16x32_bf16 v[56:59], v[64:67], v[120:123], v[56:59]
  v_mfma_f32_16x16x32_bf16 v[60:63], v[64:67], v[124:127], v[60:63]
  ds_read_b128 v[132:135], v4 offset:3072
  ds_read_b128 v[164:167], v5 offset:512
  v_mfma_f32_16x16x32_bf16 v[36:39], v[68:71], v[96:99], v[36:39]
  v_mfma_f32_16x16x32_bf16 v[40:43], v[68:71], v[100:103], v[40:43]
  v_mfma_f32_16x16x32_bf16 v[44:47], v[68:71], v[104:107], v[44:47]
  v_mfma_f32_16x16x32_bf16 v[48:51], v[68:71], v[108:111], v[48:51]
  ds_read_b128 v[136:139], v4 offset:2560
  ds_read_b128 v[168:171], v5 offset:1024
  v_mfma_f32_16x16x32_bf16 v[52:55], v[68:71], v[112:115], v[52:55]
  v_mfma_f32_16x16x32_bf16 v[56:59], v[68:71], v[116:119], v[56:59]
  v_mfma_f32_16x16x32_bf16 v[60:63], v[68:71], v[120:123], v[60:63]
  v_mfma_f32_16x16x32_bf16 v[40:43], v[72:75], v[96:99], v[40:43]
  ds_read_b128 v[140:143], v4 offset:2048
  ds_read_b128 v[172:175], v5 offset:1536
  v_mfma_f32_16x16x32_bf16 v[44:47], v[72:75], v[100:103], v[44:47]
  v_mfma_f32_16x16x32_bf16 v[48:51], v[72:75], v[104:107], v[48:51]
  v_mfma_f32_16x16x32_bf16 v[52:55], v[72:75], v[108:111], v[52:55]
  v_mfma_f32_16x16x32_bf16 v[56:59], v[72:75], v[112:115], v[56:59]
  ds_read_b128 v[144:147], v4 offset:1536
  ds_read_b128 v[176:179], v5 offset:2048
  v_mfma_f32_16x16x32_bf16 v[60:63], v[72:75], v[116:119], v[60:63]
  v_mfma_f32_16x16x32_bf16 v[44:47], v[76:79], v[96:99], v[44:47]
  v_mfma_f32_16x16x32_bf16 v[48:51], v[76:79], v[100:103], v[48:51]
  v_mfma_f32_16x16x32_bf16 v[52:55], v[76:79], v[104:107], v[52:55]
  ds_read_b128 v[148:151], v4 offset:1024
  ds_read_b128 v[180:183], v5 offset:2560
  v_mfma_f32_16x16x32_bf16 v[56:59], v[76:79], v[108:111], v[56:59]
  v_mfma_f32_16x16x32_bf16 v[60:63], v[76:79], v[112:115], v[60:63]
  v_mfma_f32_16x16x32_bf16 v[48:51], v[80:83], v[96:99], v[48:51]
  v_mfma_f32_16x16x32_bf16 v[52:55], v[80:83], v[100:103], v[52:55]
  ds_read_b128 v[152:155], v4 offset:512
  ds_read_b128 v[184:187], v5 offset:3072
  v_mfma_f32_16x16x32_bf16 v[56:59], v[80:83], v[104:107], v[56:59]
  v_mfma_f32_16x16x32_bf16 v[60:63], v[80:83], v[108:111], v[60:63]
  v_mfma_f32_16x16x32_bf16 v[52:55], v[84:87], v[96:99], v[52:55]
  v_mfma_f32_16x16x32_bf16 v[56:59], v[84:87], v[100:103], v[56:59]
  ds_read_b128 v[156:159], v4 offset:0
  ds_read_b128 v[188:191], v5 offset:3584
  v_mfma_f32_16x16x32_bf16 v[60:63], v[84:87], v[104:107], v[60:63]
  v_mfma_f32_16x16x32_bf16 v[56:59], v[88:91], v[96:99], v[56:59]
  v_mfma_f32_16x16x32_bf16 v[60:63], v[88:91], v[100:103], v[60:63]
  v_mfma_f32_16x16x32_bf16 v[60:63], v[92:95], v[96:99], v[60:63]
  v_subrev_u32 v4, 64, v4
  v_subrev_u32 v5, 64, v5
  s_waitcnt lgkmcnt(0)
  v_mfma_f32_16x16x32_bf16 v[32:35], v[128:131], v[160:163], v[32:35]
  v_mfma_f32_16x16x32_bf16 v[36:39], v[128:131], v[164:167], v[36:39]
  v_mfma_f32_16x16x32_bf16 v[40:43], v[128:131], v[168:171], v[40:43]
  v_mfma_f32_16x16x32_bf16 v[44:47], v[128:131], v[172:175], v[44:47]
  ds_read_b128 v[64:67], v4 offset:3584
  ds_read_b128 v[96:99], v5 offset:0
  v_mfma_f32_16x16x32_bf16 v[48:51], v[128:131], v[176:179], v[48:51]
  v_mfma_f32_16x16x32_bf16 v[52:55], v[128:131], v[180:183], v[52:55]
  v_mfma_f32_16x16x32_bf16 v[56:59], v[128:131], v[184:187], v[56:59]
  v_mfma_f32_16x16x32_bf16 v[60:63], v[128:131], v[188:191], v[60:63]
  ds_read_b128 v[68:71], v4 offset:3072
  ds_read_b128 v[100:103], v5 offset:512
  v_mfma_f32_16x16x32_bf16 v[36:39], v[132:135], v[160:163], v[36:39]
  v_mfma_f32_16x16x32_bf16 v[40:43], v[132:135], v[164:167], v[40:43]
  v_mfma_f32_16x16x32_bf16 v[44:47], v[132:135], v[168:171], v[44:47]
  v_mfma_f32_16x16x32_bf16 v[48:51], v[132:135], v[172:175], v[48:51]
  ds_read_b128 v[72:75], v4 offset:2560
  ds_read_b128 v[104:107], v5 offset:1024
  v_mfma_f32_16x16x32_bf16 v[52:55], v[132:135], v[176:179], v[52:55]
  v_mfma_f32_16x16x32_bf16 v[56:59], v[132:135], v[180:183], v[56:59]
  v_mfma_f32_16x16x32_bf16 v[60:63], v[132:135], v[184:187], v[60:63]
  v_mfma_f32_16x16x32_bf16 v[40:43], v[136:139], v[160:163], v[40:43]
  ds_read_b128 v[76:79], v4 offset:2048
  ds_read_b128 v[108:111], v5 offset:1536
  v_mfma_f32_16x16x32_bf16 v[44:47], v[136:139], v[164:167], v[44:47]
  v_mfma_f32_16x16x32_bf16 v[48:51], v[136:139], v[168:171], v[48:51]
  v_mfma_f32_16x16x32_bf16 v[52:55], v[136:139], v[172:175], v[52:55]
  v_mfma_f32_16x16x32_bf16 v[56:59], v[136:139], v[176:179], v[56:59]
  ds_read_b128 v[80:83], v4 offset:1536
  ds_read_b128 v[112:115], v5 offset:2048
  v_mfma_f32_16x16x32_bf16 v[60:63], v[136:139], v[180:183], v[60:63]
  v_mfma_f32_16x16x32_bf16 v[44:47], v[140:143], v[160:163], v[44:47]
  v_mfma_f32_16x16x32_bf16 v[48:51], v[140:143], v[164:167], v[48:51]
  v_mfma_f32_16x16x32_bf16 v[52:55], v[140:143], v[168:171], v[52:55]
  ds_read_b128 v[84:87], v4 offset:1024
  ds_read_b128 v[116:119], v5 offset:2560
  v_mfma_f32_16x16x32_bf16 v[56:59], v[140:143], v[172:175], v[56:59]
  v_mfma_f32_16x16x32_bf16 v[60:63], v[140:143], v[176:179], v[60:63]
  v_mfma_f32_16x16x32_bf16 v[48:51], v[144:147], v[160:163], v[48:51]
  v_mfma_f32_16x16x32_bf16 v[52:55], v[144:147], v[164:167], v[52:55]
  ds_read_b128 v[88:91], v4 offset:512
  ds_read_b128 v[120:123], v5 offset:3072
  v_mfma_f32_16x16x32_bf16 v[56:59], v[144:147], v[168:171], v[56:59]
  v_mfma_f32_16x16x32_bf16 v[60:63], v[144:147], v[172:175], v[60:63]
  v_mfma_f32_16x16x32_bf16 v[52:55], v[148:151], v[160:163], v[52:55]
  v_mfma_f32_16x16x32_bf16 v[56:59], v[148:151], v[164:167], v[56:59]
  ds_read_b128 v[92:95], v4 offset:0
  ds_read_b128 v[124:127], v5 offset:3584
  v_mfma_f32_16x16x32_bf16 v[60:63], v[148:151], v[168:171], v[60:63]
  v_mfma_f32_16x16x32_bf16 v[56:59], v[152:155], v[160:163], v[56:59]
  v_mfma_f32_16x16x32_bf16 v[60:63], v[152:155], v[164:167], v[60:63]
  v_mfma_f32_16x16x32_bf16 v[60:63], v[156:159], v[160:163], v[60:63]
  v_subrev_u32 v4, 64, v4
  v_subrev_u32 v5, 64, v5
  s_add_u32 s35, s35, 1
  s_cmp_lt_u32 s35, 2
  s_cbranch_scc1 L_cv_loop
L_cv_done:
  s_setprio 3
  s_waitcnt lgkmcnt(0)
  s_barrier
  s_lshl_b32 s30, s14, 12
  v_add_u32 v6, s30, v3
  s_xor_b32 s31, s14, 1
  s_lshl_b32 s31, s31, 12
  v_add_u32 v11, s31, v3
  s_cmp_eq_u32 s28, 0
  s_cbranch_scc0 L_cv_w1
  ds_write_b128 v6, v[48:51] offset:0
  ds_write_b128 v6, v[52:55] offset:1024
  ds_write_b128 v6, v[56:59] offset:2048
  ds_write_b128 v6, v[60:63] offset:3072
  s_branch L_cv_w2
L_cv_w1:
  ds_write_b128 v6, v[32:35] offset:0
  ds_write_b128 v6, v[36:39] offset:1024
  ds_write_b128 v6, v[40:43] offset:2048
  ds_write_b128 v6, v[44:47] offset:3072
  v_mov_b32 v32, v48
  v_mov_b32 v33, v49
  v_mov_b32 v34, v50
  v_mov_b32 v35, v51
  v_mov_b32 v36, v52
  v_mov_b32 v37, v53
  v_mov_b32 v38, v54
  v_mov_b32 v39, v55
  v_mov_b32 v40, v56
  v_mov_b32 v41, v57
  v_mov_b32 v42, v58
  v_mov_b32 v43, v59
  v_mov_b32 v44, v60
  v_mov_b32 v45, v61
  v_mov_b32 v46, v62
  v_mov_b32 v47, v63
L_cv_w2:
  v_and_b32 v8, 15, v1
  v_lshlrev_b32 v8, 5, v8
  v_lshrrev_b32 v9, 4, v1
  v_lshl_add_u32 v8, v9, 3, v8
  s_lshl_b32 s30, s28, 11
  s_add_u32 s30, s30, s34
  s_add_u32 s30, s30, 512
  v_add_u32 v9, s30, v8
  ds_read_b64 v[80:81], v9 offset:0
  ds_read_b64 v[82:83], v9 offset:512
  ds_read_b64 v[84:85], v9 offset:1024
  ds_read_b64 v[86:87], v9 offset:1536
  v_lshlrev_b32 v7, 16, v7
  s_waitcnt lgkmcnt(0)
  s_barrier
  ds_read_b128 v[64:67], v11 offset:0
  ds_read_b128 v[68:71], v11 offset:1024
  ds_read_b128 v[72:75], v11 offset:2048
  ds_read_b128 v[76:79], v11 offset:3072
  s_waitcnt lgkmcnt(0)
  v_add_f32 v32, v32, v64
  v_add_f32 v33, v33, v65
  v_add_f32 v34, v34, v66
  v_add_f32 v35, v35, v67
  v_add_f32 v36, v36, v68
  v_add_f32 v37, v37, v69
  v_add_f32 v38, v38, v70
  v_add_f32 v39, v39, v71
  v_add_f32 v40, v40, v72
  v_add_f32 v41, v41, v73
  v_add_f32 v42, v42, v74
  v_add_f32 v43, v43, v75
  v_add_f32 v44, v44, v76
  v_add_f32 v45, v45, v77
  v_add_f32 v46, v46, v78
  v_add_f32 v47, v47, v79
  v_lshlrev_b32 v96, 16, v80
  v_and_b32 v97, 0xffff0000, v80
  v_lshlrev_b32 v98, 16, v81
  v_and_b32 v99, 0xffff0000, v81
  v_lshlrev_b32 v100, 16, v82
  v_and_b32 v101, 0xffff0000, v82
  v_lshlrev_b32 v102, 16, v83
  v_and_b32 v103, 0xffff0000, v83
  v_lshlrev_b32 v104, 16, v84
  v_and_b32 v105, 0xffff0000, v84
  v_lshlrev_b32 v106, 16, v85
  v_and_b32 v107, 0xffff0000, v85
  v_lshlrev_b32 v108, 16, v86
  v_and_b32 v109, 0xffff0000, v86
  v_lshlrev_b32 v110, 16, v87
  v_and_b32 v111, 0xffff0000, v87
  v_fmac_f32 v32, v96, v7
  v_fmac_f32 v33, v97, v7
  v_fmac_f32 v34, v98, v7
  v_fmac_f32 v35, v99, v7
  v_fmac_f32 v36, v100, v7
  v_fmac_f32 v37, v101, v7
  v_fmac_f32 v38, v102, v7
  v_fmac_f32 v39, v103, v7
  v_fmac_f32 v40, v104, v7
  v_fmac_f32 v41, v105, v7
  v_fmac_f32 v42, v106, v7
  v_fmac_f32 v43, v107, v7
  v_fmac_f32 v44, v108, v7
  v_fmac_f32 v45, v109, v7
  v_fmac_f32 v46, v110, v7
  v_fmac_f32 v47, v111, v7
  v_cvt_pk_bf16_f32 v112, v32, v33
  v_cvt_pk_bf16_f32 v113, v34, v35
  v_cvt_pk_bf16_f32 v114, v36, v37
  v_cvt_pk_bf16_f32 v115, v38, v39
  v_cvt_pk_bf16_f32 v116, v40, v41
  v_cvt_pk_bf16_f32 v117, v42, v43
  v_cvt_pk_bf16_f32 v118, v44, v45
  v_cvt_pk_bf16_f32 v119, v46, v47
  s_lshl_b32 s30, s14, 11
  s_add_u32 s30, s30, 16384
  v_add_u32 v9, s30, v8
  ds_write_b64 v9, v[112:113] offset:0
  ds_write_b64 v9, v[114:115] offset:512
  ds_write_b64 v9, v[116:117] offset:1024
  ds_write_b64 v9, v[118:119] offset:1536
  v_add_u32 v9, s30, v3
  s_waitcnt lgkmcnt(0)
  ds_read_b128 v[72:75], v9
  ds_read_b128 v[76:79], v9 offset:1024
  s_lshl_b32 s30, s29, 12
  s_lshl_b32 s31, s28, 11
  s_add_u32 s30, s30, s31
  s_waitcnt lgkmcnt(0)
  buffer_store_dwordx4 v[72:75], v3, s[24:27], s30 offen sc1
  buffer_store_dwordx4 v[76:79], v3, s[24:27], s30 offen offset:1024 sc1
  s_lshl_b32 s30, s47, 4
  s_waitcnt vmcnt(0)
  s_barrier
  v_cmp_eq_u32 vcc, 0, v0
  s_nop 0
  s_and_saveexec_b64 s[44:45], vcc
  s_add_u32 s30, s30, 9216
  v_mov_b32 v90, s30
  v_mov_b32 v91, s48
  buffer_store_dword v91, v90, s[36:39], 0 offen sc1
  s_mov_b64 exec, s[44:45]
  s_endpgm
L_nots:
  s_cmp_lt_u32 s2, 512
  s_cbranch_scc1 L_lnb
  s_endpgm
L_lna:
  s_sub_u32 s3, s2, 224
  s_branch L_ln
L_lnb:
  s_sub_u32 s3, s2, 448
L_ln:
  s_setprio 1
  s_load_dwordx2 s[4:5], s[0:1], 0
  s_load_dwordx2 s[6:7], s[0:1], 88
  s_load_dwordx4 s[8:11], s[0:1], 104
  v_and_b32 v1, 63, v0
  v_lshrrev_b32 v2, 6, v0
  s_nop 0
  v_readfirstlane_b32 s14, v2
  s_min_u32 s33, s3, 55
  s_mul_i32 s30, s33, 28672
  s_mul_i32 s31, s14, 7168
  s_add_u32 s30, s30, s31
  v_lshlrev_b32 v7, 4, v1
  s_waitcnt lgkmcnt(0)
  s_mov_b32 s20, s6
  s_mov_b32 s21, s7
  s_mov_b32 s22, 1605632
  s_mov_b32 s23, 0x00020000
  s_add_u32 m0, s31, 32768
  s_add_u32 s32, s30, 0
  buffer_load_dwordx4 v7, s[20:23], s32 offen lds
  s_add_u32 m0, s31, 33792
  s_add_u32 s32, s30, 1024
  buffer_load_dwordx4 v7, s[20:23], s32 offen lds
  s_add_u32 m0, s31, 34816
  s_add_u32 s32, s30, 2048
  buffer_load_dwordx4 v7, s[20:23], s32 offen lds
  s_add_u32 m0, s31, 35840
  s_add_u32 s32, s30, 3072
  buffer_load_dwordx4 v7, s[20:23], s32 offen lds
  s_add_u32 m0, s31, 36864
  s_add_u32 s32, s30, 4096
  buffer_load_dwordx4 v7, s[20:23], s32 offen lds
  s_add_u32 m0, s31, 37888
  s_add_u32 s32, s30, 5120
  buffer_load_dwordx4 v7, s[20:23], s32 offen lds
  s_add_u32 m0, s31, 38912
  s_add_u32 s32, s30, 6144
  buffer_load_dwordx4 v7, s[20:23], s32 offen lds
  s_mov_b32 s16, s4
  s_mov_b32 s17, s5
  s_mov_b32 s18, 1835008
  s_mov_b32 s19, 0x00020000
  s_and_b32 s47, s3, 31
  s_add_u32 s47, s47, 224
  s_lshl_b32 s30, s47, 3
  s_lshl_b32 s31, s14, 1
  s_add_u32 s30, s30, s31
  v_lshrrev_b32 v36, 5, v1
  v_add_u32 v36, s30, v36
  v_and_b32 v37, 31, v1
  v_mul_u32_u24 v38, 896, v36
  v_lshl_add_u32 v38, v37, 4, v38
  v_mov_b32 v44, 0
  v_mov_b32 v45, 0
  v_mov_b32 v46, 0
  v_mov_b32 v47, 0
  buffer_load_dwordx4 v[40:43], v38, s[16:19], 0 offen
  s_mov_b32 exec_lo, 0x00ffffff
  s_mov_b32 exec_hi, 0x00ffffff
  buffer_load_dwordx4 v[44:47], v38, s[16:19], 0 offen offset:512
  s_mov_b64 exec, -1
  s_mov_b32 s52, s8
  s_mov_b32 s53, s9
  s_mov_b32 s54, 256
  s_mov_b32 s55, 0x00020000
  v_mov_b32 v120, 0
  s_mov_b32 s24, s10
  s_mov_b32 s25, s11
  s_mov_b32 s26, 1835008
  s_mov_b32 s27, 0x00020000
  s_add_u32 s36, s10, 1835008
  s_addc_u32 s37, s11, 0
  s_mov_b32 s38, 8192
  s_mov_b32 s39, 0x00020000
  s_add_u32 s40, s10, 12582912
  s_addc_u32 s41, s11, 0
  s_mov_b32 s42, 1605632
  s_mov_b32 s43, 0x00020000
  s_add_u32 s56, s10, 16777216
  s_addc_u32 s57, s11, 0
  s_mov_b32 s58, 65536
  s_mov_b32 s59, 0x00020000
  v_lshrrev_b32 v80, 5, v1
  v_bfe_u32 v81, v1, 2, 2
  s_lshr_b32 s30, s14, 1
  v_lshl_add_u32 v80, v80, 2, v81
  v_bfe_u32 v82, v1, 4, 1
  v_mul_u32_u24 v80, 896, v80
  s_and_b32 s31, s14, 1
  s_mul_i32 s31, s31, 7
  v_lshl_add_u32 v80, v82, 5, v80
  v_and_b32 v83, 3, v1
  s_mul_i32 s32, s30, 14336
  s_lshl_b32 s34, s31, 6
  s_add_u32 s32, s32, s34
  v_lshl_add_u32 v80, v83, 3, v80
  s_lshl_b32 s35, s33, 1
  s_add_u32 s35, s35, s30
  v_add_u32 v80, 32768, v80
  s_mul_i32 s35, s35, 14
  s_add_u32 s35, s35, s31
  v_add_u32 v80, s32, v80
  s_lshl_b32 s35, s35, 10
  s_waitcnt vmcnt(2)
  buffer_load_dword v121, v120, s[52:55], 0 offen sc1
  s_barrier
  ds_read_b64_tr_b16 v[84:85], v80 offset:0
  ds_read_b64_tr_b16 v[86:87], v80 offset:7168
  ds_read_b64_tr_b16 v[88:89], v80 offset:64
  ds_read_b64_tr_b16 v[90:91], v80 offset:7232
  ds_read_b64_tr_b16 v[92:93], v80 offset:128
  ds_read_b64_tr_b16 v[94:95], v80 offset:7296
  ds_read_b64_tr_b16 v[96:97], v80 offset:192
  ds_read_b64_tr_b16 v[98:99], v80 offset:7360
  ds_read_b64_tr_b16 v[100:101], v80 offset:256
  ds_read_b64_tr_b16 v[102:103], v80 offset:7424
  ds_read_b64_tr_b16 v[104:105], v80 offset:320
  ds_read_b64_tr_b16 v[106:107], v80 offset:7488
  ds_read_b64_tr_b16 v[108:109], v80 offset:384
  ds_read_b64_tr_b16 v[110:111], v80 offset:7552
  s_waitcnt lgkmcnt(0) vmcnt(0)
  v_readfirstlane_b32 s48, v121
  s_cmp_ge_u32 s3, 56
  s_cbranch_scc1 L_ln_now2
  buffer_store_dwordx4 v[84:87], v7, s[40:43], s35 offen sc1
  s_add_u32 s35, s35, 1024
  buffer_store_dwordx4 v[88:91], v7, s[40:43], s35 offen sc1
  s_add_u32 s35, s35, 1024
  buffer_store_dwordx4 v[92:95], v7, s[40:43], s35 offen sc1
  s_add_u32 s35, s35, 1024
  buffer_store_dwordx4 v[96:99], v7, s[40:43], s35 offen sc1
  s_add_u32 s35, s35, 1024
  buffer_store_dwordx4 v[100:103], v7, s[40:43], s35 offen sc1
  s_add_u32 s35, s35, 1024
  buffer_store_dwordx4 v[104:107], v7, s[40:43], s35 offen sc1
  s_add_u32 s35, s35, 1024
  buffer_store_dwordx4 v[108:111], v7, s[40:43], s35 offen sc1
  s_add_u32 s35, s35, 1024
L_ln_now2:
  s_cmp_lg_u32 s48, 0
  s_cbranch_scc1 L_ln_haven
  v_mov_b32 v112, 0
  s_mov_b32 s49, 0
L_nonce14:
  buffer_load_dword v113, v112, s[52:55], 0 offen sc1
  s_waitcnt vmcnt(0)
  v_readfirstlane_b32 s48, v113
  s_nop 3
  s_cmp_lg_u32 s48, 0
  s_cbranch_scc1 L_nonce_e15
  s_add_u32 s49, s49, 1
  s_cmp_lt_u32 s49, 200000
  s_sleep 1
  s_cbranch_scc1 L_nonce14
L_nonce_e15:
L_ln_haven:
  s_cmp_ge_u32 s3, 32
  s_cbranch_scc1 L_ln_noln
  v_lshlrev_b32 v48, 16, v40
  v_and_b32 v49, 0xffff0000, v40
  v_lshlrev_b32 v50, 16, v41
  v_and_b32 v51, 0xffff0000, v41
  v_lshlrev_b32 v52, 16, v42
  v_and_b32 v53, 0xffff0000, v42
  v_lshlrev_b32 v54, 16, v43
  v_and_b32 v55, 0xffff0000, v43
  v_lshlrev_b32 v56, 16, v44
  v_and_b32 v57, 0xffff0000, v44
  v_lshlrev_b32 v58, 16, v45
  v_and_b32 v59, 0xffff0000, v45
  v_add_f32 v64, v48, v52
  v_add_f32 v65, v49, v53
  v_add_f32 v66, v50, v54
  v_add_f32 v67, v51, v55
  v_lshlrev_b32 v60, 16, v46
  v_and_b32 v61, 0xffff0000, v46
  v_lshlrev_b32 v62, 16, v47
  v_and_b32 v63, 0xffff0000, v47
  v_add_f32 v64, v64, v56
  v_add_f32 v65, v65, v57
  v_add_f32 v66, v66, v58
  v_add_f32 v67, v67, v59
  v_add_f32 v64, v64, v60
  v_add_f32 v65, v65, v61
  v_add_f32 v66, v66, v62
  v_add_f32 v67, v67, v63
  v_add_f32 v64, v64, v65
  v_add_f32 v66, v66, v67
  v_add_f32 v64, v64, v66
  s_nop 1
  v_add_f32_dpp v64, v64, v64 quad_perm:[1,0,3,2] row_mask:0xf bank_mask:0xf
  s_nop 1
  v_add_f32_dpp v64, v64, v64 quad_perm:[2,3,0,1] row_mask:0xf bank_mask:0xf
  s_nop 1
  v_add_f32_dpp v64, v64, v64 row_half_mirror row_mask:0xf bank_mask:0xf
  s_nop 1
  v_add_f32_dpp v64, v64, v64 row_mirror row_mask:0xf bank_mask:0xf
  ds_swizzle_b32 v65, v64 offset:0x401F
  s_waitcnt lgkmcnt(0)
  v_add_f32 v64, v64, v65
  v_mul_f32 v64, 0xbb124925, v64
  v_add_f32 v68, v48, v64
  v_add_f32 v69, v49, v64
  v_add_f32 v70, v50, v64
  v_add_f32 v71, v51, v64
  v_mul_f32 v65, v68, v68
  v_mul_f32 v66, v69, v69
  v_add_f32 v72, v52, v64
  v_add_f32 v73, v53, v64
  v_fmac_f32 v65, v70, v70
  v_fmac_f32 v66, v71, v71
  v_add_f32 v74, v54, v64
  v_add_f32 v75, v55, v64
  v_fmac_f32 v65, v72, v72
  v_fmac_f32 v66, v73, v73
  v_fmac_f32 v65, v74, v74
  v_fmac_f32 v66, v75, v75
  s_mov_b32 exec_lo, 0x00ffffff
  s_mov_b32 exec_hi, 0x00ffffff
  v_add_f32 v68, v56, v64
  v_add_f32 v69, v57, v64
  v_add_f32 v70, v58, v64
  v_add_f32 v71, v59, v64
  v_fmac_f32 v65, v68, v68
  v_fmac_f32 v66, v69, v69
  v_add_f32 v72, v60, v64
  v_add_f32 v73, v61, v64
  v_fmac_f32 v65, v70, v70
  v_fmac_f32 v66, v71, v71
  v_add_f32 v74, v62, v64
  v_add_f32 v75, v63, v64
  v_fmac_f32 v65, v72, v72
  v_fmac_f32 v66, v73, v73
  v_fmac_f32 v65, v74, v74
  v_fmac_f32 v66, v75, v75
  s_mov_b64 exec, -1
  v_add_f32 v65, v65, v66
  s_nop 1
  v_add_f32_dpp v65, v65, v65 quad_perm:[1,0,3,2] row_mask:0xf bank_mask:0xf
  s_nop 1
  v_add_f32_dpp v65, v65, v65 quad_perm:[2,3,0,1] row_mask:0xf bank_mask:0xf
  s_nop 1
  v_add_f32_dpp v65, v65, v65 row_half_mirror row_mask:0xf bank_mask:0xf
  s_nop 1
  v_add_f32_dpp v65, v65, v65 row_mirror row_mask:0xf bank_mask:0xf
  ds_swizzle_b32 v66, v65 offset:0x401F
  s_waitcnt lgkmcnt(0)
  v_add_f32 v65, v65, v66
  v_mul_f32 v65, 0x3b124925, v65
  v_cvt_pk_bf16_f32 v65, v65, v64
  v_and_b32 v64, 0xffff0000, v65
  v_lshlrev_b32 v65, 16, v65
  v_add_f32 v65, 0x3727c5ac, v65
  v_cvt_pk_bf16_f32 v65, v65, v65
  v_lshlrev_b32 v65, 16, v65
  v_sqrt_f32 v65, v65
  s_nop 0
  v_cvt_pk_bf16_f32 v65, v65, v65
  v_lshlrev_b32 v65, 16, v65
  v_rcp_f32 v66, v65
  s_nop 0
  v_fma_f32 v67, -v65, v66, 2.0
  v_mul_f32 v66, v66, v67
  v_lshlrev_b32 v39, 2, v36
  s_mov_b32 exec_lo, 1
  s_mov_b32 exec_hi, 1
  buffer_store_dword v66, v39, s[36:39], 0 offen sc1
  s_mov_b64 exec, -1
  v_add_f32 v48, v48, v64
  v_add_f32 v49, v49, v64
  v_add_f32 v50, v50, v64
  v_add_f32 v51, v51, v64
  v_add_f32 v52, v52, v64
  v_add_f32 v53, v53, v64
  v_add_f32 v54, v54, v64
  v_add_f32 v55, v55, v64
  v_add_f32 v56, v56, v64
  v_add_f32 v57, v57, v64
  v_add_f32 v58, v58, v64
  v_add_f32 v59, v59, v64
  v_add_f32 v60, v60, v64
  v_add_f32 v61, v61, v64
  v_add_f32 v62, v62, v64
  v_add_f32 v63, v63, v64
  v_bfe_u32 v69, v1, 2, 2
  v_cvt_pk_bf16_f32 v40, v48, v49
  v_cvt_pk_bf16_f32 v41, v50, v51
  v_cvt_pk_bf16_f32 v42, v52, v53
  v_cvt_pk_bf16_f32 v43, v54, v55
  v_cvt_pk_bf16_f32 v44, v56, v57
  v_cvt_pk_bf16_f32 v45, v58, v59
  v_cvt_pk_bf16_f32 v46, v60, v61
  v_cvt_pk_bf16_f32 v47, v62, v63
  v_mul_u32_u24 v69, 960, v69
  v_lshrrev_b32 v70, 4, v1
  v_and_b32 v68, 7, v36
  v_lshl_add_u32 v69, v70, 5, v69
  v_lshlrev_b32 v48, 16, v40
  v_and_b32 v49, 0xffff0000, v40
  v_lshlrev_b32 v50, 16, v41
  v_and_b32 v51, 0xffff0000, v41
  v_lshlrev_b32 v52, 16, v42
  v_and_b32 v53, 0xffff0000, v42
  v_lshlrev_b32 v54, 16, v43
  v_and_b32 v55, 0xffff0000, v43
  v_lshlrev_b32 v56, 16, v44
  v_and_b32 v57, 0xffff0000, v44
  v_lshlrev_b32 v58, 16, v45
  v_and_b32 v59, 0xffff0000, v45
  v_lshlrev_b32 v60, 16, v46
  v_and_b32 v61, 0xffff0000, v46
  v_lshlrev_b32 v62, 16, v47
  v_and_b32 v63, 0xffff0000, v47
  v_mul_u32_u24 v68, 960, v68
  v_and_b32 v70, 3, v1
  v_mul_f32 v48, v48, v66
  v_mul_f32 v49, v49, v66
  v_mul_f32 v50, v50, v66
  v_mul_f32 v51, v51, v66
  v_mul_f32 v52, v52, v66
  v_mul_f32 v53, v53, v66
  v_mul_f32 v54, v54, v66
  v_mul_f32 v55, v55, v66
  v_mul_f32 v56, v56, v66
  v_mul_f32 v57, v57, v66
  v_mul_f32 v58, v58, v66
  v_mul_f32 v59, v59, v66
  v_mul_f32 v60, v60, v66
  v_mul_f32 v61, v61, v66
  v_mul_f32 v62, v62, v66
  v_mul_f32 v63, v63, v66
  v_lshl_add_u32 v68, v37, 4, v68
  v_lshl_add_u32 v69, v70, 3, v69
  s_lshl_b32 s44, s14, 7
  s_add_u32 s44, s44, 0
  v_cvt_pk_bf16_f32 v40, v48, v49
  v_cvt_pk_bf16_f32 v41, v50, v51
  v_cvt_pk_bf16_f32 v42, v52, v53
  v_cvt_pk_bf16_f32 v43, v54, v55
  v_cvt_pk_bf16_f32 v44, v56, v57
  v_cvt_pk_bf16_f32 v45, v58, v59
  v_cvt_pk_bf16_f32 v46, v60, v61
  v_cvt_pk_bf16_f32 v47, v62, v63
  v_add_u32 v68, 0, v68
  v_add_u32 v69, s44, v69
  v_lshlrev_b32 v70, 4, v1
  ds_write_b128 v68, v[40:43]
  s_mov_b32 exec_lo, 0x00ffffff
  s_mov_b32 exec_hi, 0x00ffffff
  ds_write_b128 v68, v[44:47] offset:512
  s_mov_b64 exec, -1
  s_mul_i32 s44, s47, 7168
  s_lshl_b32 s45, s14, 10
  s_add_u32 s44, s44, s45
  s_waitcnt lgkmcnt(0)
  s_barrier
  ds_read_b64_tr_b16 v[72:73], v69
  ds_read_b64_tr_b16 v[74:75], v69 offset:3840
  ds_read_b64_tr_b16 v[76:77], v69 offset:512
  ds_read_b64_tr_b16 v[78:79], v69 offset:4352
  s_waitcnt lgkmcnt(2)
  buffer_store_dwordx4 v[72:75], v70, s[24:27], s44 offen sc1
  s_cmp_eq_u32 s14, 3
  s_cbranch_scc1 L_ln816
  s_add_u32 s44, s44, 4096
  s_waitcnt lgkmcnt(0)
  buffer_store_dwordx4 v[76:79], v70, s[24:27], s44 offen sc1
L_ln816:
  s_waitcnt lgkmcnt(0)
  s_lshl_b32 s30, s47, 4
  s_waitcnt vmcnt(0)
  s_barrier
  v_cmp_eq_u32 vcc, 0, v0
  s_nop 0
  s_and_saveexec_b64 s[44:45], vcc
  s_add_u32 s30, s30, 0
  v_mov_b32 v112, s30
  v_mov_b32 v113, s48
  buffer_store_dword v113, v112, s[56:59], 0 offen sc1
  s_mov_b64 exec, s[44:45]
L_ln_noln:
  s_lshl_b32 s30, s3, 4
  s_waitcnt vmcnt(0)
  s_barrier
  v_cmp_eq_u32 vcc, 0, v0
  s_nop 0
  s_and_saveexec_b64 s[44:45], vcc
  s_add_u32 s30, s30, 4096
  v_mov_b32 v112, s30
  v_mov_b32 v113, s48
  buffer_store_dword v113, v112, s[56:59], 0 offen sc1
  s_mov_b64 exec, s[44:45]
  s_endpgm
.section .rodata,"a"
.p2align 6
.amdhsa_kernel parallel_sum__ssm_conv_s4__dense_activation_relu__prompt_kernel
  .amdhsa_next_free_vgpr 256
  .amdhsa_next_free_sgpr 102
  .amdhsa_accum_offset 256
  .amdhsa_group_segment_fixed_size 0
  .amdhsa_kernarg_size 120
  .amdhsa_user_sgpr_count 2
  .amdhsa_user_sgpr_kernarg_segment_ptr 1
  .amdhsa_system_sgpr_workgroup_id_x 1
.end_amdhsa_kernel
```
